```python
import torch

def _softmax(x, axis=-1):
    return torch.softmax(x, dim=axis)

def _gelu(x):
    return torch.nn.functional.gelu(x, approximate='tanh')

def _silu(x):
    return torch.nn.functional.silu(x)

def _sigmoid(x):
    return torch.sigmoid(x)

def _layernorm(x, axis=-1, eps=1e-05):
    m = x.mean(dim=axis, keepdim=True)
    v = x.var(dim=axis, keepdim=True, unbiased=False)
    return (x - m) / torch.sqrt(v + eps)

def _scatter_add(tgt, idx, src, axis=0):
    return tgt.clone().index_add_(axis, idx, src)

def _segment_sum(src, seg, n):
    out = torch.zeros((n,) + src.shape[1:], dtype=src.dtype)
    return out.index_add_(0, seg, src)

def _pad(x, pw):
    flat = tuple((v for pair in reversed(pw) for v in pair))
    return torch.nn.functional.pad(x, flat)
kernel_name = 'gather_scatter__tensor_product_equiv_equiformer__graph'

def setup_inputs():

    _w = lambda a: (lambda t: t.to(torch.bfloat16) if t.is_floating_point() else t)(torch.as_tensor(a))
    N, deg, C, De = (10000, 16, 128, max(16, 1))
    E = N * deg
    src = (lambda lo, hi, *s: torch.randint(lo, hi, s))(0, N, E).to(torch.int64)
    dst = (lambda lo, hi, *s: torch.randint(lo, hi, s))(0, N, E).to(torch.int64)
    rvec = (lambda *s: torch.randn(*s, dtype=torch.bfloat16) * 0.05)(E, 3).to(float)
    rn = (torch.linalg.norm(rvec, dim=-1, keepdim=True) + 1e-06).to(float)
    rhat = (rvec / rn).to(float)
    eps = torch.zeros((3, 3, 3), dtype=float)
    eps[0, 1, 2] = eps[1, 2, 0] = eps[2, 0, 1] = 1.0
    eps[0, 2, 1] = eps[2, 1, 0] = eps[1, 0, 2] = -1.0
    return {'x': _w((lambda *s: torch.randn(*s, dtype=torch.bfloat16) * 0.2)(N, 4 * C).to(float)), 'rhat': _w(rhat), 'e_attr': _w((lambda *s: torch.randn(*s, dtype=torch.bfloat16) * 0.2)(E, De).to(float)), 'src': _w(src), 'dst': _w(dst), 'w_rad': _w((lambda *s: torch.randn(*s, dtype=torch.bfloat16) * 0.2)(De, 5 * C).to(float)), 'w_si0': _w((lambda *s: torch.randn(*s, dtype=torch.bfloat16) * 0.2)(2 * C, C).to(float)), 'w_si1': _w((lambda *s: torch.randn(*s, dtype=torch.bfloat16) * 0.05)(3 * C, C).to(float)), 'cg_eps': _w(eps)}

def reference(x, rhat, e_attr, src, dst, w_rad, w_si0, w_si1, cg_eps):
    N = x.shape[0]
    C = w_si0.shape[1]
    E = rhat.shape[0]
    x0 = x[:, :C].clone()
    x1 = x[:, C:].reshape(N, 3, C)
    R = (e_attr @ w_rad).reshape(E, 5, C)
    f0 = x0[src]
    f1 = x1[src]
    Y1 = rhat
    p00_0 = f0 * R[:, 0, :]
    p11_0 = torch.einsum('ejc,ej->ec', f1, Y1) * R[:, 1, :]
    p01_1 = torch.einsum('ec,ej->ejc', f0, Y1) * R[:, 2, :][:, None, :]
    p10_1 = f1 * R[:, 3, :][:, None, :]
    p11_1 = torch.einsum('ijk,ekc,ej->eic', cg_eps, f1, Y1) * R[:, 4, :][:, None, :]
    m0 = torch.concatenate([p00_0, p11_0], axis=-1) @ w_si0
    m1 = torch.einsum('ejp,pc->ejc', torch.concatenate([p01_1, p10_1, p11_1], axis=-1), w_si1)
    agg0 = _segment_sum(m0, dst, N)
    agg1 = _segment_sum(m1.reshape(E, 3 * C), dst, N).reshape(N, 3, C)
    gate = _sigmoid(agg0)
    out1 = agg1 * gate[:, None, :]
    return torch.concatenate([agg0, out1.reshape(N, 3 * C)], axis=-1)
```

```asm
; @launch kernel=sort_kernel grid=(250,1,1) block=(640,1,1) lds=35840
; @launch kernel=gather_scatter__tensor_product_equiv_equiformer__graph_kernel grid=(256,1,1) block=(512,1,1) lds=163200
.amdgcn_target "amdgcn-amd-amdhsa--gfx950"
.text
.globl sort_kernel
.p2align 8
.type sort_kernel,@function
sort_kernel:
    s_cmp_ge_u32 s2, 250
    s_cbranch_scc1 A_end
    s_load_dwordx16 s[36:51], s[0:1], 0
    s_load_dwordx2 s[52:53], s[0:1], 88
    s_mul_i32 s3, s2, 640
    v_add_u32 v1, s3, v0
    v_lshlrev_b32 v2, 2, v1
    v_mul_u32_u24 v3, 6, v1
    v_lshlrev_b32 v4, 5, v1
    v_lshlrev_b32 v5, 2, v0
    v_mov_b32 v6, 0
    v_lshrrev_b32 v7, 6, v0
    ds_write_b32 v5, v6
    v_and_b32 v30, 63, v0
    v_mov_b32 v42, 0
    v_readfirstlane_b32 s54, v7
    s_waitcnt lgkmcnt(0)
    s_mov_b32 s4, s44
    s_and_b32 s5, s45, 0xffff
    s_mov_b32 s6, 640000
    s_mov_b32 s7, 0x20000
    buffer_load_dword v8, v2, s[4:7], 0 offen
    s_mov_b32 s8, s42
    s_and_b32 s9, s43, 0xffff
    s_mov_b32 s10, 640000
    s_mov_b32 s11, 0x20000
    buffer_load_dword v9, v2, s[8:11], 0 offen
    s_mov_b32 s12, s38
    s_and_b32 s13, s39, 0xffff
    s_mov_b32 s14, 960000
    s_mov_b32 s15, 0x20000
    buffer_load_ushort v10, v3, s[12:15], 0 offen
    buffer_load_ushort v11, v3, s[12:15], 0 offen offset:2
    buffer_load_ushort v12, v3, s[12:15], 0 offen offset:4
    s_mov_b32 s16, s40
    s_and_b32 s17, s41, 0xffff
    s_mov_b32 s18, 5120000
    s_mov_b32 s19, 0x20000
    s_barrier
    buffer_load_dwordx4 v[16:19], v4, s[16:19], 0 offen
    buffer_load_dwordx4 v[20:23], v4, s[16:19], 0 offen offset:16
    s_mov_b32 s20, s52
    s_and_b32 s21, s53, 0xffff
    s_mov_b32 s22, 9244672
    s_mov_b32 s23, 0x20000
    s_mov_b32 s55, 214749
    s_waitcnt vmcnt(6)
    v_mul_u32_u24 v13, s55, v8
    v_lshrrev_b32 v13, 23, v13
    v_lshlrev_b32 v14, 2, v13
    v_mov_b32 v6, 1
    ds_add_rtn_u32 v15, v14, v6
    s_movk_i32 s55, 625
    v_mad_u32_u24 v13, v13, s55, 15
    v_lshrrev_b32 v13, 4, v13
    v_sub_u32 v13, v8, v13
    v_lshl_or_b32 v13, v0, 6, v13
    s_mov_b32 s56, 0
    s_cmp_lg_u32 s54, 1
    s_cbranch_scc1 A_now
    s_cmp_ge_u32 s2, 180
    s_cbranch_scc1 A_now
    s_mov_b32 s56, 1
    s_mov_b32 s61, s2
    s_mov_b32 s27, 0x20000
    s_cmp_ge_u32 s2, 160
    s_cbranch_scc1 A_rad
    s_mul_i32 s57, s2, 205
    s_lshr_b32 s57, s57, 12
    s_mul_i32 s58, s57, 20
    s_sub_u32 s58, s2, s58
    s_cmp_lt_u32 s58, 8
    s_cselect_b32 s24, s48, s50
    s_cselect_b32 s25, s49, s51
    s_mov_b32 s26, 0x18000
    s_cselect_b32 s26, 0x10000, s26
    s_cselect_b32 s59, 0, 8
    s_sub_u32 s58, s58, s59
    s_and_b32 s25, s25, 0xffff
    s_lshl_b32 s58, s58, 13
    s_lshl_b32 s57, s57, 5
    s_add_u32 s58, s58, s57
    v_lshrrev_b32 v31, 4, v30
    v_lshlrev_b32 v31, 11, v31
    v_and_b32 v32, 15, v30
    v_lshl_add_u32 v31, v32, 1, v31
    s_movk_i32 s60, 256
    s_branch A_wld
A_rad:
    s_sub_u32 s57, s2, 160
    s_mul_i32 s58, s57, 52
    s_lshr_b32 s58, s58, 8
    s_mul_i32 s59, s58, 5
    s_sub_u32 s57, s57, s59
    s_mov_b32 s61, 14780448
    s_bitcmp1_b32 s58, 0
    s_cselect_b32 s61, 17275044, s61
    s_mul_i32 s59, s57, 5
    s_lshr_b32 s61, s61, s59
    s_and_b32 s61, s61, 31
    s_cmp_ge_u32 s61, 14
    s_cselect_b32 s59, 3, 7
    s_bitcmp1_b32 s58, 1
    s_cselect_b32 s59, s59, 0
    s_add_u32 s61, s61, s59
    s_add_u32 s61, s61, 160
    s_lshl_b32 s57, s57, 8
    s_and_b32 s59, s58, 1
    s_lshl_b32 s59, s59, 1
    s_lshr_b32 s58, s58, 1
    s_lshl_b32 s58, s58, 7
    s_add_u32 s58, s58, s57
    s_add_u32 s58, s58, s59
    s_mov_b32 s24, s46
    s_and_b32 s25, s47, 0xffff
    s_mov_b32 s26, 20480
    v_lshrrev_b32 v31, 5, v30
    v_mul_u32_u24 v31, 10240, v31
    v_and_b32 v32, 31, v30
    v_lshl_add_u32 v31, v32, 2, v31
    s_movk_i32 s60, 1280
A_wld:
    buffer_load_ushort v48, v31, s[24:27], s58 offen
    s_add_u32 s58, s58, s60
    buffer_load_ushort v49, v31, s[24:27], s58 offen
    s_add_u32 s58, s58, s60
    buffer_load_ushort v50, v31, s[24:27], s58 offen
    s_add_u32 s58, s58, s60
    buffer_load_ushort v51, v31, s[24:27], s58 offen
    s_add_u32 s58, s58, s60
    buffer_load_ushort v52, v31, s[24:27], s58 offen
    s_add_u32 s58, s58, s60
    buffer_load_ushort v53, v31, s[24:27], s58 offen
    s_add_u32 s58, s58, s60
    buffer_load_ushort v54, v31, s[24:27], s58 offen
    s_add_u32 s58, s58, s60
    buffer_load_ushort v55, v31, s[24:27], s58 offen
    s_add_u32 s58, s58, s60
A_now:
    s_waitcnt lgkmcnt(0)
    s_barrier
    v_lshlrev_b32 v5, 4, v30
    ds_read_b128 v[24:27], v5
    s_waitcnt lgkmcnt(0)
    v_add_u32 v28, v24, v25
    v_add3_u32 v28, v28, v26, v27
    v_mov_b32 v29, v28
    s_nop 1
    v_add_u32_dpp v28, v28, v28 row_shr:1 row_mask:0xf bank_mask:0xf
    s_nop 1
    v_add_u32_dpp v28, v28, v28 row_shr:2 row_mask:0xf bank_mask:0xf
    s_nop 1
    v_add_u32_dpp v28, v28, v28 row_shr:4 row_mask:0xf bank_mask:0xf
    s_nop 1
    v_add_u32_dpp v28, v28, v28 row_shr:8 row_mask:0xf bank_mask:0xf
    s_nop 1
    v_add_u32_dpp v28, v28, v28 row_bcast:15 row_mask:0xa bank_mask:0xf
    s_nop 1
    v_add_u32_dpp v28, v28, v28 row_bcast:31 row_mask:0xc bank_mask:0xf
    v_sub_u32 v32, v28, v29
    v_add_u32 v33, v32, v24
    v_add_u32 v34, v33, v25
    v_add_u32 v35, v34, v26
    ds_write_b128 v5, v[32:35] offset:4096
    ds_read_b32 v14, v14 offset:4096
    s_cmp_lg_u32 s54, 0
    s_cbranch_scc1 A_notab
    v_lshl_or_b32 v24, v24, 16, v32
    v_lshl_or_b32 v25, v25, 16, v33
    v_lshl_or_b32 v26, v26, 16, v34
    v_lshl_or_b32 v27, v27, 16, v35
    v_lshrrev_b32 v28, 1, v30
    v_and_b32 v29, 1, v30
    v_lshlrev_b32 v29, 4, v29
    v_lshl_add_u32 v42, v28, 13, v29
A_notab:
    s_waitcnt vmcnt(10)
    s_cmp_lg_u32 s56, 0
    s_cbranch_scc1 A_ld1
    s_waitcnt vmcnt(2)
A_ld1:
    v_xor_b32 v28, 0x8000, v11
    v_xor_b32 v29, 0x8000, v12
    v_xor_b32 v31, 0x8000, v10
    v_lshl_or_b32 v44, v10, 16, v28
    v_lshl_or_b32 v45, v11, 16, v29
    v_lshl_or_b32 v46, v12, 16, v31
    v_lshl_or_b32 v47, v13, 16, v9
    s_waitcnt lgkmcnt(0)
    v_add_lshl_u32 v14, v14, v15, 4
    v_lshlrev_b32 v15, 1, v14
    ds_write_b128 v14, v[44:47] offset:5120
    v_lshlrev_b32 v14, 4, v0
    s_mul_i32 s57, s2, 10240
    s_lshl_b32 s58, s57, 1
    s_add_u32 s57, s57, 524288
    s_add_u32 s58, s58, 3084288
    s_add_u32 s59, s58, 10240
    s_waitcnt lgkmcnt(0)
    s_barrier
    ds_read_b128 v[44:47], v14 offset:5120
    s_waitcnt lgkmcnt(0)
    buffer_store_dwordx4 v[44:47], v14, s[20:23], s57 offen sc1
    s_waitcnt vmcnt(1)
    ds_write_b128 v15, v[16:19] offset:15360
    ds_write_b128 v15, v[20:23] offset:15376
    s_cmp_lg_u32 s54, 0
    s_cbranch_scc1 A_nt2
    s_lshl_b32 s62, s2, 5
    buffer_store_dwordx4 v[24:27], v42, s[20:23], s62 offen
A_nt2:
    s_waitcnt lgkmcnt(0)
    s_barrier
    ds_read_b128 v[16:19], v14 offset:15360
    ds_read_b128 v[20:23], v14 offset:25600
    s_waitcnt lgkmcnt(1)
    buffer_store_dwordx4 v[16:19], v14, s[20:23], s58 offen sc1
    s_waitcnt lgkmcnt(0)
    buffer_store_dwordx4 v[20:23], v14, s[20:23], s59 offen sc1
    s_cmp_eq_u32 s56, 0
    s_cbranch_scc1 A_fin
    s_lshl_b32 s57, s61, 10
    s_add_u32 s57, s57, 262144
    s_waitcnt vmcnt(3)
    v_lshl_or_b32 v36, v49, 16, v48
    v_lshl_or_b32 v37, v51, 16, v50
    v_lshl_or_b32 v38, v53, 16, v52
    v_lshl_or_b32 v39, v55, 16, v54
    buffer_store_dwordx4 v[36:39], v5, s[20:23], s57 offen
A_fin:
A_end:
    s_endpgm
.globl gather_scatter__tensor_product_equiv_equiformer__graph_kernel
.p2align 8
.type gather_scatter__tensor_product_equiv_equiformer__graph_kernel,@function
gather_scatter__tensor_product_equiv_equiformer__graph_kernel:
    s_cmp_ge_u32 s2, 256
    s_cbranch_scc1 B_end
    s_load_dwordx2 s[4:5], s[0:1], 0
    s_load_dwordx2 s[6:7], s[0:1], 72
    s_load_dwordx2 s[64:65], s[0:1], 88
    s_load_dwordx2 s[66:67], s[0:1], 16
    s_and_b32 s3, s2, 7
    s_lshl_b32 s3, s3, 5
    s_lshr_b32 s58, s2, 3
    s_add_u32 s58, s58, s3
    v_mov_b32 v249, v0
    v_and_b32 v251, 63, v0
    v_lshrrev_b32 v1, 6, v0
    v_lshrrev_b32 v2, 1, v0
    v_readfirstlane_b32 s34, v1
    v_lshlrev_b32 v2, 5, v2
    s_lshr_b32 s3, s58, 3
    s_lshl_b32 s3, s3, 11
    s_lshr_b32 s62, s2, 3
    s_and_b32 s62, s62, 7
    s_add_u32 s3, s3, s62
    s_lshl_b32 s3, s3, 2
    v_lshlrev_b32 v3, 4, v0
    v_mov_b32 v250, 0
    v_cmp_gt_u32 vcc, 500, v0
    s_mov_b32 s61, 524288
    s_waitcnt lgkmcnt(0)
    s_mov_b32 s12, s64
    s_and_b32 s13, s65, 0xffff
    s_mov_b32 s14, 9244672
    s_mov_b32 s15, 0x20000
    s_mov_b64 exec, vcc
    buffer_load_dword v250, v2, s[12:15], s3 offen
    s_mov_b64 exec, -1
    s_mov_b32 s64, 3084288
    s_barrier
    s_mov_b32 s3, 425984
    buffer_load_dwordx4 v[128:131], v3, s[12:15], s3 offen
    s_add_u32 s3, s3, 8192
    buffer_load_dwordx4 v[132:135], v3, s[12:15], s3 offen
    s_add_u32 s3, s3, 8192
    v_lshlrev_b32 v140, 3, v249
    buffer_load_dwordx2 v[136:137], v140, s[12:15], s3 offen
    s_mov_b32 s16, s6
    s_and_b32 s17, s7, 0xffff
    s_mov_b32 s18, 10240000
    s_mov_b32 s19, 0x20000
    s_mov_b32 s8, s66
    s_and_b32 s9, s67, 0xffff
    s_mov_b32 s10, 5120000
    s_mov_b32 s11, 0x20000
    s_mul_i32 s3, s58, 625
    s_add_u32 s59, s3, 15
    s_lshr_b32 s59, s59, 4
    s_add_u32 s3, s3, 640
    s_lshr_b32 s3, s3, 4
    s_sub_u32 s60, s3, s59
    s_mov_b32 s35, 0
    s_mov_b32 s36, 14
    s_mov_b32 s54, 0xffff0000
    s_mov_b32 s55, 0xffff0000
    s_mov_b32 s56, 0xffff
    s_mov_b32 s57, 0xffff
    s_mov_b32 s96, 0x3f80
    s_mov_b32 s97, 0x3f800000
    v_mov_b32 v19, 0xa5
    v_mov_b32 v20, 0x84
    v_and_b32 v10, 31, v251
    v_lshlrev_b32 v207, 2, v10
    v_lshrrev_b32 v11, 5, v251
    v_lshlrev_b32 v248, 4, v11
    v_bfe_u32 v12, v251, 2, 1
    v_bfe_u32 v13, v251, 4, 1
    v_xor_b32 v13, v13, v12
    v_and_b32 v14, 1, v251
    v_xor_b32 v14, v14, v11
    v_or_b32 v13, v13, v14
    v_bfe_u32 v14, v251, 1, 1
    v_lshl_or_b32 v13, v13, 1, v14
    v_bfe_u32 v15, v251, 3, 1
    v_cmp_eq_u32 vcc, 1, v13
    v_mov_b32 v16, 3
    v_lshlrev_b32 v17, 3, v15
    v_cndmask_b32 v233, 0, v16, vcc
    v_mul_u32_u24 v239, v233, v15
    v_cmp_eq_u32 vcc, 0, v13
    v_mov_b32 v16, 32
    v_add_u32 v14, 16, v17
    v_cndmask_b32 v234, v16, v17, vcc
    v_cndmask_b32 v14, v16, v14, vcc
    v_lshl_or_b32 v234, v14, 8, v234
    s_mov_b32 s99, 0x07060302
    v_mul_u32_u24 v14, 171, v0
    v_lshrrev_b32 v14, 11, v14
    v_mul_u32_u24 v14, 12, v14
    v_sub_u32 v14, v0, v14
    v_lshrrev_b32 v15, v14, v19
    v_and_b32 v15, 1, v15
    v_mul_u32_u24 v15, 0x3f80, v15
    v_lshrrev_b32 v14, v14, v20
    v_and_b32 v14, 1, v14
    v_lshlrev_b32 v14, 4, v14
    v_lshlrev_b32 v16, v14, v15
    v_lshlrev_b32 v18, 2, v0
    v_add_u32 v18, 161344, v18
    v_cmp_gt_u32 vcc, 192, v0
    s_mov_b64 exec, vcc
    s_cbranch_execz B_noc
    ds_write_b32 v18, v16
B_noc:
    s_mov_b64 exec, -1
    v_bfe_u32 v16, v251, 3, 2
    v_and_b32 v17, 3, v251
    v_lshl_add_u32 v16, v16, 2, v17
    v_xor_b32 v16, 8, v16
    v_lshl_add_u32 v16, v16, 1, v12
    v_lshlrev_b32 v255, 2, v16
    s_lshl_b32 s3, s34, 2
    s_add_u32 s3, s3, 163152
    v_lshl_add_u32 v253, v251, 20, s3
    s_waitcnt vmcnt(3)
B_round:
    v_and_b32 v44, 1, v249
    v_add_u32 v44, s35, v44
    v_lshrrev_b32 v45, 16, v250
    s_add_u32 s3, s35, s36
    v_min_u32 v46, s3, v45
    v_and_b32 v47, 0xffff, v250
    v_lshrrev_b32 v48, 1, v249
    v_mul_u32_u24 v48, 640, v48
    v_add3_u32 v47, v47, v48, v44
    v_lshlrev_b32 v43, 5, v47
    v_lshlrev_b32 v47, 4, v47
    v_cmp_lt_u32 s[20:21], v44, v46
    v_add_u32 v44, 2, v44
    v_cmp_lt_u32 s[22:23], v44, v46
    v_add_u32 v44, 2, v44
    v_cmp_lt_u32 s[24:25], v44, v46
    v_add_u32 v44, 2, v44
    v_cmp_lt_u32 s[26:27], v44, v46
    v_add_u32 v44, 2, v44
    v_cmp_lt_u32 s[28:29], v44, v46
    v_add_u32 v44, 2, v44
    v_cmp_lt_u32 s[30:31], v44, v46
    v_add_u32 v44, 2, v44
    v_cmp_lt_u32 s[32:33], v44, v46
    v_add_u32 v44, 2, v44
    s_mov_b64 exec, s[20:21]
    s_cbranch_execz B_ld_done
    buffer_load_dwordx4 v[0:3], v47, s[12:15], s61 offen offset:0
    s_mov_b64 exec, s[22:23]
    s_cbranch_execz B_ld_done
    buffer_load_dwordx4 v[4:7], v47, s[12:15], s61 offen offset:32
    s_mov_b64 exec, s[24:25]
    s_cbranch_execz B_ld_done
    buffer_load_dwordx4 v[8:11], v47, s[12:15], s61 offen offset:64
    s_mov_b64 exec, s[26:27]
    s_cbranch_execz B_ld_done
    buffer_load_dwordx4 v[12:15], v47, s[12:15], s61 offen offset:96
    s_mov_b64 exec, s[28:29]
    s_cbranch_execz B_ld_done
    buffer_load_dwordx4 v[16:19], v47, s[12:15], s61 offen offset:128
    s_mov_b64 exec, s[30:31]
    s_cbranch_execz B_ld_done
    buffer_load_dwordx4 v[20:23], v47, s[12:15], s61 offen offset:160
    s_mov_b64 exec, s[32:33]
    s_cbranch_execz B_ld_done
    buffer_load_dwordx4 v[24:27], v47, s[12:15], s61 offen offset:192
B_ld_done:
    s_mov_b64 exec, -1
    s_cmp_lg_u32 s36, 14
    s_cbranch_scc1 B_now
    s_cmp_lg_u32 s35, 0
    s_cbranch_scc1 B_now
    s_cmp_eq_u64 s[32:33], 0
    s_cbranch_scc1 B_wk7
    s_waitcnt vmcnt(7)
    s_branch B_wk0
B_wk7:
    s_cmp_eq_u64 s[30:31], 0
    s_cbranch_scc1 B_wk6
    s_waitcnt vmcnt(6)
    s_branch B_wk0
B_wk6:
    s_cmp_eq_u64 s[28:29], 0
    s_cbranch_scc1 B_wk5
    s_waitcnt vmcnt(5)
    s_branch B_wk0
B_wk5:
    s_cmp_eq_u64 s[26:27], 0
    s_cbranch_scc1 B_wk4
    s_waitcnt vmcnt(4)
    s_branch B_wk0
B_wk4:
    s_cmp_eq_u64 s[24:25], 0
    s_cbranch_scc1 B_wk3
    s_waitcnt vmcnt(3)
    s_branch B_wk0
B_wk3:
    s_cmp_eq_u64 s[22:23], 0
    s_cbranch_scc1 B_wk2
    s_waitcnt vmcnt(2)
    s_branch B_wk0
B_wk2:
    s_cmp_eq_u64 s[20:21], 0
    s_cbranch_scc1 B_wk1
    s_waitcnt vmcnt(1)
    s_branch B_wk0
B_wk1:
    s_waitcnt vmcnt(0)
B_wk0:
    v_lshlrev_b32 v141, 4, v249
    v_add_u32 v141, 113920, v141
    ds_write_b128 v141, v[128:131]
    s_cmp_ge_u32 s34, 6
    s_movk_i32 s3, 8192
    s_cselect_b32 s3, -120064, s3
    v_add_u32 v141, s3, v141
    ds_write_b128 v141, v[132:135]
    ds_write_b64 v140, v[136:137] offset:2048
B_now:
    v_lshlrev_b32 v49, 4, v249
    v_add_u32 v50, 128256, v49
    v_mov_b32 v52, 0
    v_mov_b32 v53, 0
    v_mov_b32 v54, 0
    v_mov_b32 v55, 0
    v_mov_b32 v56, 0x7fff0000
    v_mov_b32 v57, 0x7fff0000
    v_lshlrev_b32 v51, 3, v249
    v_add_u32 v51, 158336, v51
    v_cmp_gt_u32 vcc, 376, v249
    ds_write_b128 v50, v[52:55]
    ds_write_b128 v50, v[52:55] offset:8192
    ds_write_b128 v50, v[52:55] offset:16384
    s_mov_b64 exec, vcc
    ds_write_b64 v51, v[56:57]
    v_cmp_gt_u32 vcc, 344, v249
    s_mov_b64 exec, vcc
    ds_write_b128 v50, v[52:55] offset:24576
    s_mov_b64 exec, -1
    v_lshlrev_b32 v58, 2, v251
    v_add_u32 v58, 162112, v58
    s_cmp_lg_u32 s34, 0
    s_cbranch_scc1 B_i1
    v_sub_u32 v59, 63, v251
    ds_write_b32 v58, v59
    ds_write_b32 v58, v52 offset:256
    v_cmp_eq_u32 vcc, 12, v251
    v_mov_b32 v59, -1
    v_mov_b32 v60, 0x1000
    v_cndmask_b32 v59, v59, v60, vcc
    v_cmp_gt_u32 vcc, 4, v251
    s_mov_b64 exec, 0xffff
    s_nop 0
    v_cndmask_b32 v59, v59, v52, vcc
    ds_write_b32 v58, v59 offset:1024
    s_mov_b64 exec, -1
B_i1:
    s_waitcnt lgkmcnt(0)
    s_barrier
    s_cmp_lg_u32 s36, 14
    s_cbranch_scc1 B_now2
    s_cmp_lg_u32 s35, 0
    s_cbranch_scc1 B_now2
    v_lshlrev_b32 v59, 4, v251
    ds_read_b128 v[168:171], v59 offset:0
    ds_read_b128 v[172:175], v59 offset:1024
    ds_read_b128 v[176:179], v59 offset:2048
    ds_read_b128 v[180:183], v59 offset:3072
    ds_read_b128 v[212:215], v59 offset:4096
    ds_read_b128 v[228:231], v59 offset:5120
B_now2:
    v_mov_b32 v59, 163136
    v_cmp_gt_u32 vcc, v45, v46
    s_mov_b64 exec, vcc
    s_cbranch_execz B_nomax
    ds_max_u32 v59, v45
B_nomax:
    s_mov_b64 exec, -1
    v_mov_b32 v60, 64
    s_waitcnt vmcnt(0)
    s_mov_b32 s3, 162112
    s_mov_b64 exec, s[20:21]
    v_bfe_u32 v36, v3, 16, 6
    v_lshl_add_u32 v36, v36, 2, s3
    ds_add_rtn_u32 v28, v36, v60
    s_mov_b64 exec, s[22:23]
    v_bfe_u32 v37, v7, 16, 6
    v_lshl_add_u32 v37, v37, 2, s3
    ds_add_rtn_u32 v29, v37, v60
    s_mov_b64 exec, s[24:25]
    s_cbranch_execz B_c_done
    v_bfe_u32 v38, v11, 16, 6
    v_lshl_add_u32 v38, v38, 2, s3
    ds_add_rtn_u32 v30, v38, v60
    s_mov_b64 exec, s[26:27]
    s_cbranch_execz B_c_done
    v_bfe_u32 v39, v15, 16, 6
    v_lshl_add_u32 v39, v39, 2, s3
    ds_add_rtn_u32 v31, v39, v60
    s_mov_b64 exec, s[28:29]
    s_cbranch_execz B_c_done
    v_bfe_u32 v40, v19, 16, 6
    v_lshl_add_u32 v40, v40, 2, s3
    ds_add_rtn_u32 v32, v40, v60
    s_mov_b64 exec, s[30:31]
    s_cbranch_execz B_c_done
    v_bfe_u32 v41, v23, 16, 6
    v_lshl_add_u32 v41, v41, 2, s3
    ds_add_rtn_u32 v33, v41, v60
    s_mov_b64 exec, s[32:33]
    s_cbranch_execz B_c_done
    v_bfe_u32 v42, v27, 16, 6
    v_lshl_add_u32 v42, v42, 2, s3
    ds_add_rtn_u32 v34, v42, v60
B_c_done:
    s_mov_b64 exec, -1
    v_and_b32 v124, 1, v249
    v_add_u32 v125, -2, v45
    v_mul_i32_i24 v124, v124, v125
    v_lshl_add_u32 v124, v124, 5, v43
    s_mov_b64 exec, s[20:21]
    s_cbranch_execz B_noep
    buffer_load_dword v254, v124, s[12:15], s64 offen
B_noep:
    s_mov_b64 exec, -1
    s_lshl_b32 s3, s2, 3
    s_add_u32 s3, s3, s34
    s_mul_i32 s3, s3, 20
    v_add_u32 v122, s3, v251
    v_min_u32 v122, 39999, v122
    v_lshlrev_b32 v122, 8, v122
    s_mov_b64 exec, 1048575
    global_load_dword v254, v122, s[4:5] offset:0
    s_mov_b64 exec, -1
    v_and_b32 v88, 0xffff0000, v0
    v_and_b32 v89, 0xffff0000, v1
    v_and_b32 v90, 0xffff0000, v2
    v_and_b32 v91, 0xffff, v3
    v_min_u32 v91, 9999, v91
    v_lshlrev_b32 v91, 10, v91
    v_lshrrev_b32 v126, 16, v0
    v_alignbit_b32 v127, v0, v2, 16
    v_alignbit_b32 v128, v1, v1, 16
    v_mov_b32 v129, v88
    v_perm_b32 v130, v1, v2, s99
    v_and_b32 v131, 0xffff, v2
    v_add_u32 v3, 0, v43
    s_waitcnt lgkmcnt(0)
    s_barrier
    ds_read_b32 v61, v58
    ds_read_b32 v62, v59
    s_mul_i32 s3, s34, 5
    v_mov_b32 v63, 0
    v_and_b32 v92, 0xffff0000, v4
    v_and_b32 v93, 0xffff0000, v5
    v_and_b32 v94, 0xffff0000, v6
    v_and_b32 v95, 0xffff, v7
    v_min_u32 v95, 9999, v95
    v_lshlrev_b32 v95, 10, v95
    v_lshrrev_b32 v132, 16, v4
    v_alignbit_b32 v133, v4, v6, 16
    v_alignbit_b32 v134, v5, v5, 16
    v_mov_b32 v135, v92
    v_perm_b32 v136, v5, v6, s99
    v_and_b32 v137, 0xffff, v6
    v_add_u32 v7, 64, v43
    s_waitcnt lgkmcnt(0)
    v_readfirstlane_b32 s37, v62
    v_readlane_b32 s38, v61, s3
    s_add_u32 s3, s3, 1
    v_readlane_b32 s40, v61, s3
    s_add_u32 s3, s3, 1
    v_readlane_b32 s42, v61, s3
    s_add_u32 s3, s3, 1
    v_readlane_b32 s44, v61, s3
    s_add_u32 s3, s3, 1
    v_readlane_b32 s46, v61, s3
    s_add_u32 s3, s3, 1
    v_cmp_gt_u32 s[38:39], s38, v61
    v_cmp_gt_u32 s[40:41], s40, v61
    v_cmp_gt_u32 s[42:43], s42, v61
    v_cmp_gt_u32 s[44:45], s44, v61
    v_cmp_gt_u32 s[46:47], s46, v61
    v_addc_co_u32 v63, vcc, 0, v63, s[38:39]
    v_addc_co_u32 v63, vcc, 0, v63, s[40:41]
    v_addc_co_u32 v63, vcc, 0, v63, s[42:43]
    v_addc_co_u32 v63, vcc, 0, v63, s[44:45]
    v_addc_co_u32 v63, vcc, 0, v63, s[46:47]
    ds_add_u32 v58, v63 offset:256
    s_cmp_eq_u64 s[26:27], 0
    s_cbranch_scc1 B_pj
    v_and_b32 v100, 0xffff0000, v12
    v_and_b32 v101, 0xffff0000, v13
    v_and_b32 v102, 0xffff0000, v14
    v_and_b32 v103, 0xffff, v15
    v_min_u32 v103, 9999, v103
    v_lshlrev_b32 v103, 10, v103
    v_lshrrev_b32 v144, 16, v12
    v_alignbit_b32 v145, v12, v14, 16
    v_alignbit_b32 v146, v13, v13, 16
    v_mov_b32 v147, v100
    v_perm_b32 v148, v13, v14, s99
    v_and_b32 v149, 0xffff, v14
    v_add_u32 v15, 192, v43
    s_cmp_eq_u64 s[28:29], 0
    s_cbranch_scc1 B_pj
    v_and_b32 v104, 0xffff0000, v16
    v_and_b32 v105, 0xffff0000, v17
    v_and_b32 v106, 0xffff0000, v18
    v_and_b32 v107, 0xffff, v19
    v_min_u32 v107, 9999, v107
    v_lshlrev_b32 v107, 10, v107
    v_lshrrev_b32 v150, 16, v16
    v_alignbit_b32 v151, v16, v18, 16
    v_alignbit_b32 v152, v17, v17, 16
    v_mov_b32 v153, v104
    v_perm_b32 v154, v17, v18, s99
    v_and_b32 v155, 0xffff, v18
    v_add_u32 v19, 256, v43
    s_cmp_eq_u64 s[30:31], 0
    s_cbranch_scc1 B_pj
    v_and_b32 v108, 0xffff0000, v20
    v_and_b32 v109, 0xffff0000, v21
    v_and_b32 v110, 0xffff0000, v22
    v_and_b32 v111, 0xffff, v23
    v_min_u32 v111, 9999, v111
    v_lshlrev_b32 v111, 10, v111
    v_lshrrev_b32 v156, 16, v20
    v_alignbit_b32 v157, v20, v22, 16
    v_alignbit_b32 v158, v21, v21, 16
    v_mov_b32 v159, v108
    v_perm_b32 v160, v21, v22, s99
    v_and_b32 v161, 0xffff, v22
    v_add_u32 v23, 320, v43
    s_cmp_eq_u64 s[32:33], 0
    s_cbranch_scc1 B_pj
    v_and_b32 v112, 0xffff0000, v24
    v_and_b32 v113, 0xffff0000, v25
    v_and_b32 v114, 0xffff0000, v26
    v_and_b32 v115, 0xffff, v27
    v_min_u32 v115, 9999, v115
    v_lshlrev_b32 v115, 10, v115
    v_lshrrev_b32 v162, 16, v24
    v_alignbit_b32 v163, v24, v26, 16
    v_alignbit_b32 v164, v25, v25, 16
    v_mov_b32 v165, v112
    v_perm_b32 v166, v25, v26, s99
    v_and_b32 v167, 0xffff, v26
    v_add_u32 v27, 384, v43
B_pj:
    s_waitcnt lgkmcnt(0)
    s_barrier
    v_cmp_gt_u32 vcc, 40, v251
    ds_read_b32 v63, v58 offset:256
    v_and_b32 v96, 0xffff0000, v8
    v_and_b32 v97, 0xffff0000, v9
    v_and_b32 v98, 0xffff0000, v10
    v_and_b32 v99, 0xffff, v11
    v_min_u32 v99, 9999, v99
    v_lshlrev_b32 v99, 10, v99
    v_lshrrev_b32 v138, 16, v8
    v_alignbit_b32 v139, v8, v10, 16
    v_alignbit_b32 v140, v9, v9, 16
    v_mov_b32 v141, v96
    v_perm_b32 v142, v9, v10, s99
    v_and_b32 v143, 0xffff, v10
    v_add_u32 v11, 128, v43
    s_waitcnt lgkmcnt(0)
    v_cndmask_b32 v63, v251, v63, vcc
    v_lshlrev_b32 v63, 2, v63
    ds_permute_b32 v64, v63, v61
    v_and_b32 v65, 1, v251
    s_waitcnt lgkmcnt(0)
    v_lshrrev_b32 v66, 6, v64
    v_and_b32 v64, 63, v64
    v_sub_u32 v64, 63, v64
    v_mov_b32_dpp v67, v66 quad_perm:[0,0,2,2] row_mask:0xf bank_mask:0xf
    v_mov_b32_dpp v68, v66 quad_perm:[0,0,2,2] row_mask:0xf bank_mask:0xf
    s_nop 1
    v_add_u32_dpp v68, v68, v68 row_shr:2 row_mask:0xf bank_mask:0xf
    s_nop 1
    v_add_u32_dpp v68, v68, v68 row_shr:4 row_mask:0xf bank_mask:0xf
    s_nop 1
    v_add_u32_dpp v68, v68, v68 row_shr:8 row_mask:0xf bank_mask:0xf
    s_nop 1
    v_add_u32_dpp v68, v68, v68 row_bcast:15 row_mask:0xa bank_mask:0xf
    s_nop 1
    v_add_u32_dpp v68, v68, v68 row_bcast:31 row_mask:0xc bank_mask:0xf
    v_sub_u32 v69, v68, v67
    v_readlane_b32 s3, v68, 63
    v_lshl_add_u32 v69, v69, 1, v65
    v_lshlrev_b32 v70, 2, v64
    v_add_u32 v70, 162624, v70
    ds_write_b32 v70, v69
    v_cmp_eq_u32 vcc, 0, v67
    v_mul_u32_u24 v64, 2848, v64
    v_mov_b32 v70, 0x100000
    s_add_u32 s3, s3, 7
    s_lshr_b32 s3, s3, 3
    v_cndmask_b32 v64, v64, v70, vcc
    v_cndmask_b32 v246, v68, v70, vcc
    ds_write_b32 v58, v64 offset:768
    s_max_u32 s38, s3, 16
    s_cmp_le_u32 s38, 47
    s_cbranch_scc1 B_fit
    s_cmp_gt_u32 s36, 2
    s_cselect_b32 s36, 2, 1
    s_waitcnt vmcnt(0) lgkmcnt(0)
    s_barrier
    s_branch B_round
B_fit:
    v_cvt_f32_u32 v71, s38
    v_rcp_f32 v71, v71
    s_mov_b32 s62, 146144
    v_mul_f32 v72, 0.5, v71
    v_mov_b32 v79, 128256
    v_readlane_b32 s3, v67, 38
    s_or_b32 s3, s3, s35
    s_cbranch_scc1 B_nozero
    v_mov_b32 v64, 0
    v_mov_b32 v65, 0
    v_mov_b32 v66, 0
    v_mov_b32 v67, 0
    v_lshlrev_b32 v120, 4, v249
    v_add_u32 v121, 0x10000, v120
    ds_write_b128 v120, v[64:67] offset:0
    ds_write_b128 v120, v[64:67] offset:8192
    ds_write_b128 v120, v[64:67] offset:16384
    ds_write_b128 v120, v[64:67] offset:24576
    ds_write_b128 v120, v[64:67] offset:32768
    ds_write_b128 v120, v[64:67] offset:40960
    ds_write_b128 v120, v[64:67] offset:49152
    ds_write_b128 v120, v[64:67] offset:57344
    ds_write_b128 v121, v[64:67] offset:0
    ds_write_b128 v121, v[64:67] offset:8192
    ds_write_b128 v121, v[64:67] offset:16384
    ds_write_b128 v121, v[64:67] offset:24576
    ds_write_b128 v121, v[64:67] offset:32768
    v_cmp_gt_u32 vcc, 464, v249
    s_mov_b64 exec, vcc
    ds_write_b128 v121, v[64:67] offset:40960
    s_mov_b64 exec, -1
B_nozero:
    s_mov_b64 exec, s[20:21]
    ds_read_b32 v36, v36 offset:512
    s_mov_b64 exec, s[22:23]
    ds_read_b32 v37, v37 offset:512
    s_mov_b64 exec, s[24:25]
    s_cbranch_execz B_n_done
    ds_read_b32 v38, v38 offset:512
    s_mov_b64 exec, s[26:27]
    s_cbranch_execz B_n_done
    ds_read_b32 v39, v39 offset:512
    s_mov_b64 exec, s[28:29]
    s_cbranch_execz B_n_done
    ds_read_b32 v40, v40 offset:512
    s_mov_b64 exec, s[30:31]
    s_cbranch_execz B_n_done
    ds_read_b32 v41, v41 offset:512
    s_mov_b64 exec, s[32:33]
    s_cbranch_execz B_n_done
    ds_read_b32 v42, v42 offset:512
B_n_done:
    s_mov_b64 exec, -1
    s_mul_i32 s40, s34, s38
    s_add_u32 s42, s40, s38
    s_mov_b32 s41, s40
    s_cmp_eq_u32 s35, 0
    s_cselect_b32 s63, s42, 0
    s_and_b32 s3, s38, 15
    s_sub_u32 s39, 16, s3
    s_lshr_b32 s47, s38, 4
    s_lshl_b32 s51, s38, 5
    s_sub_u32 s53, 512, s51
    s_mov_b32 s46, 0
    s_movk_i32 s48, 512
    s_mov_b32 s50, 0
    s_mov_b32 s52, 0
    v_cmp_ge_u32 vcc, s40, v246
    v_lshrrev_b32 v80, 2, v248
    v_mov_b32 v247, v207
    v_mov_b32 v237, v207
    v_lshlrev_b32 v240, 4, v251
    s_bcnt1_i32_b64 s44, vcc
    s_mov_b32 s45, s44
    v_add_u32 v240, 113920, v240
    s_lshl_b32 s3, s44, 2
    s_add_u32 s3, s3, 162880
    v_add_u32 v244, s3, v80
    v_mov_b32 v80, s51
    s_waitcnt lgkmcnt(0)
    s_mov_b64 exec, s[20:21]
    v_lshrrev_b32 v73, 6, v28
    v_lshl_add_u32 v73, v73, 1, v36
    v_lshrrev_b32 v75, 1, v73
    v_cvt_f32_u32 v74, v75
    v_fma_f32 v74, v74, v71, v72
    v_cvt_u32_f32 v74, v74
    v_mad_u32_u24 v74, v74, s38, 5
    v_cmp_lt_u32 vcc, v75, v74
    v_mad_u32_u24 v75, v73, 24, v79
    v_lshl_add_u32 v76, v73, 2, v79
    v_lshl_add_u32 v73, v73, 4, s62
    v_cndmask_b32 v74, 0, v80, vcc
    v_add_u32 v74, v74, v73
    ds_write2_b64 v75, v[126:127], v[128:129] offset1:1
    ds_write_b64 v75, v[130:131] offset:16
    ds_write_b32 v76, v3 offset:30080
    ds_write_b96 v73, v[88:90] offset:160
    ds_write_b32 v74, v91 offset:12
    s_mov_b64 exec, s[22:23]
    v_lshrrev_b32 v73, 6, v29
    v_lshl_add_u32 v73, v73, 1, v37
    v_lshrrev_b32 v75, 1, v73
    v_cvt_f32_u32 v74, v75
    v_fma_f32 v74, v74, v71, v72
    v_cvt_u32_f32 v74, v74
    v_mad_u32_u24 v74, v74, s38, 5
    v_cmp_lt_u32 vcc, v75, v74
    v_mad_u32_u24 v75, v73, 24, v79
    v_lshl_add_u32 v76, v73, 2, v79
    v_lshl_add_u32 v73, v73, 4, s62
    v_cndmask_b32 v74, 0, v80, vcc
    v_add_u32 v74, v74, v73
    ds_write2_b64 v75, v[132:133], v[134:135] offset1:1
    ds_write_b64 v75, v[136:137] offset:16
    ds_write_b32 v76, v7 offset:30080
    ds_write_b96 v73, v[92:94] offset:160
    ds_write_b32 v74, v95 offset:12
    s_mov_b64 exec, s[24:25]
    s_cbranch_execz B_s_done
    v_lshrrev_b32 v73, 6, v30
    v_lshl_add_u32 v73, v73, 1, v38
    v_lshrrev_b32 v75, 1, v73
    v_cvt_f32_u32 v74, v75
    v_fma_f32 v74, v74, v71, v72
    v_cvt_u32_f32 v74, v74
    v_mad_u32_u24 v74, v74, s38, 5
    v_cmp_lt_u32 vcc, v75, v74
    v_mad_u32_u24 v75, v73, 24, v79
    v_lshl_add_u32 v76, v73, 2, v79
    v_lshl_add_u32 v73, v73, 4, s62
    v_cndmask_b32 v74, 0, v80, vcc
    v_add_u32 v74, v74, v73
    ds_write2_b64 v75, v[138:139], v[140:141] offset1:1
    ds_write_b64 v75, v[142:143] offset:16
    ds_write_b32 v76, v11 offset:30080
    ds_write_b96 v73, v[96:98] offset:160
    ds_write_b32 v74, v99 offset:12
    s_mov_b64 exec, s[26:27]
    s_cbranch_execz B_s_done
    v_lshrrev_b32 v73, 6, v31
    v_lshl_add_u32 v73, v73, 1, v39
    v_lshrrev_b32 v75, 1, v73
    v_cvt_f32_u32 v74, v75
    v_fma_f32 v74, v74, v71, v72
    v_cvt_u32_f32 v74, v74
    v_mad_u32_u24 v74, v74, s38, 5
    v_cmp_lt_u32 vcc, v75, v74
    v_mad_u32_u24 v75, v73, 24, v79
    v_lshl_add_u32 v76, v73, 2, v79
    v_lshl_add_u32 v73, v73, 4, s62
    v_cndmask_b32 v74, 0, v80, vcc
    v_add_u32 v74, v74, v73
    ds_write2_b64 v75, v[144:145], v[146:147] offset1:1
    ds_write_b64 v75, v[148:149] offset:16
    ds_write_b32 v76, v15 offset:30080
    ds_write_b96 v73, v[100:102] offset:160
    ds_write_b32 v74, v103 offset:12
    s_mov_b64 exec, s[28:29]
    s_cbranch_execz B_s_done
    v_lshrrev_b32 v73, 6, v32
    v_lshl_add_u32 v73, v73, 1, v40
    v_lshrrev_b32 v75, 1, v73
    v_cvt_f32_u32 v74, v75
    v_fma_f32 v74, v74, v71, v72
    v_cvt_u32_f32 v74, v74
    v_mad_u32_u24 v74, v74, s38, 5
    v_cmp_lt_u32 vcc, v75, v74
    v_mad_u32_u24 v75, v73, 24, v79
    v_lshl_add_u32 v76, v73, 2, v79
    v_lshl_add_u32 v73, v73, 4, s62
    v_cndmask_b32 v74, 0, v80, vcc
    v_add_u32 v74, v74, v73
    ds_write2_b64 v75, v[150:151], v[152:153] offset1:1
    ds_write_b64 v75, v[154:155] offset:16
    ds_write_b32 v76, v19 offset:30080
    ds_write_b96 v73, v[104:106] offset:160
    ds_write_b32 v74, v107 offset:12
    s_mov_b64 exec, s[30:31]
    s_cbranch_execz B_s_done
    v_lshrrev_b32 v73, 6, v33
    v_lshl_add_u32 v73, v73, 1, v41
    v_lshrrev_b32 v75, 1, v73
    v_cvt_f32_u32 v74, v75
    v_fma_f32 v74, v74, v71, v72
    v_cvt_u32_f32 v74, v74
    v_mad_u32_u24 v74, v74, s38, 5
    v_cmp_lt_u32 vcc, v75, v74
    v_mad_u32_u24 v75, v73, 24, v79
    v_lshl_add_u32 v76, v73, 2, v79
    v_lshl_add_u32 v73, v73, 4, s62
    v_cndmask_b32 v74, 0, v80, vcc
    v_add_u32 v74, v74, v73
    ds_write2_b64 v75, v[156:157], v[158:159] offset1:1
    ds_write_b64 v75, v[160:161] offset:16
    ds_write_b32 v76, v23 offset:30080
    ds_write_b96 v73, v[108:110] offset:160
    ds_write_b32 v74, v111 offset:12
    s_mov_b64 exec, s[32:33]
    s_cbranch_execz B_s_done
    v_lshrrev_b32 v73, 6, v34
    v_lshl_add_u32 v73, v73, 1, v42
    v_lshrrev_b32 v75, 1, v73
    v_cvt_f32_u32 v74, v75
    v_fma_f32 v74, v74, v71, v72
    v_cvt_u32_f32 v74, v74
    v_mad_u32_u24 v74, v74, s38, 5
    v_cmp_lt_u32 vcc, v75, v74
    v_mad_u32_u24 v75, v73, 24, v79
    v_lshl_add_u32 v76, v73, 2, v79
    v_lshl_add_u32 v73, v73, 4, s62
    v_cndmask_b32 v74, 0, v80, vcc
    v_add_u32 v74, v74, v73
    ds_write2_b64 v75, v[162:163], v[164:165] offset1:1
    ds_write_b64 v75, v[166:167] offset:16
    ds_write_b32 v76, v27 offset:30080
    ds_write_b96 v73, v[112:114] offset:160
    ds_write_b32 v74, v115 offset:12
B_s_done:
    s_mov_b64 exec, -1
    s_lshl_b32 s3, s40, 5
    s_add_u32 s3, s3, 146144
    v_add_u32 v82, s3, v248
    s_lshl_b32 s62, s39, 5
    s_sub_u32 s3, s40, s39
    s_lshl_b32 s3, s3, 3
    s_add_u32 s3, s3, 158336
    v_add_u32 v83, s3, v255
    v_add_u32 v238, 128, v83
    s_mul_i32 s3, s40, 48
    s_add_u32 s3, s3, 128256
    v_lshrrev_b32 v84, 1, v248
    v_add3_u32 v84, v84, v248, s3
    v_and_b32 v85, 0xff, v234
    v_cmp_eq_u32 vcc, 3, v239
    v_add_u32 v85, 161344, v85
    v_lshrrev_b32 v78, 8, v234
    v_cndmask_b32 v85, v85, v84, vcc
    v_cmp_eq_u32 vcc, 3, v233
    v_and_b32 v77, 8, v251
    v_add3_u32 v84, v84, v77, 8
    v_add_u32 v78, 161344, v78
    v_cndmask_b32 v84, v78, v84, vcc
    s_cmp_gt_u32 s39, 15
    s_cselect_b32 s3, 512, 0
    s_sub_u32 s3, s3, s62
    s_add_u32 s3, s3, 160
    v_add_u32 v236, s3, v82
    s_cmp_gt_u32 s39, 14
    s_cselect_b32 s3, 512, 0
    s_sub_u32 s3, s3, s62
    s_ashr_i32 s3, s3, 1
    v_mad_i32_i24 v235, v239, s3, v85
    v_mad_i32_i24 v232, v233, s3, v84
    v_mov_b32 v242, v85
    v_mov_b32 v243, v84
    s_movk_i32 s98, 256
    v_add_u32 v81, s51, v82
    s_sub_u32 s3, 0x3e0, s62
    s_and_b32 s3, s3, 96
    v_add_u32 v120, s3, v81
    s_add_u32 s3, s3, 32
    s_and_b32 s3, s3, 96
    v_add_u32 v121, s3, v81
    s_add_u32 s3, s3, 32
    s_and_b32 s3, s3, 96
    v_add_u32 v122, s3, v81
    s_add_u32 s3, s3, 32
    s_and_b32 s3, s3, 96
    v_add_u32 v123, s3, v81
    s_add_u32 s3, s3, 32
    s_add_u32 s49, s39, 1
    s_and_b32 s49, s49, 3
    s_waitcnt lgkmcnt(0)
    s_barrier
    s_setprio 3
    ds_read_b32 v128, v81 offset:12
    ds_read_b32 v86, v83
    ds_read_b32 v241, v238
    ds_read_b32 v120, v120 offset:44
    ds_read_b32 v121, v121 offset:44
    ds_read_b32 v122, v122 offset:44
    ds_read_b32 v123, v123 offset:44
    ds_read_b64_tr_b16 v[208:209], v242 offset:0
    ds_read_b64_tr_b16 v[210:211], v243 offset:0
    ds_read_b128 v[216:219], v82 offset:160
    s_waitcnt lgkmcnt(7)
    v_add_u32 v128, v128, v207
    v_add_u32 v86, v248, v86
    v_add_u32 v241, v248, v241
    s_lshl_b32 s3, s39, 3
    v_cmp_gt_u32 vcc, s3, v255
    v_mov_b32 v87, 0x7fff0000
    s_cmp_gt_u32 s39, 8
    v_cndmask_b32 v86, v86, v87, vcc
    s_cselect_b64 vcc, s[54:55], 0
    s_nop 0
    v_cndmask_b32 v86, v86, v241, vcc
    buffer_load_dwordx4 v[224:227], v86, s[12:15], s64 offen
    global_load_dword v188, v128, s[4:5] offset:0
    global_load_dword v189, v128, s[4:5] offset:256
    global_load_dword v190, v128, s[4:5] offset:512
    global_load_dword v191, v128, s[4:5] offset:768
    s_waitcnt lgkmcnt(0)
    s_setprio 1
    v_add_u32 v120, v120, v207
    v_add_u32 v121, v121, v207
    v_add_u32 v122, v122, v207
    v_add_u32 v123, v123, v207
    s_cmp_eq_u32 s49, 1
    s_cbranch_scc1 B_x1
    s_cmp_eq_u32 s49, 2
    s_cbranch_scc1 B_x2
    s_cmp_eq_u32 s49, 3
    s_cbranch_scc1 B_x3
B_x0:
    global_load_dword v152, v120, s[4:5] offset:0
    global_load_dword v153, v120, s[4:5] offset:256
    global_load_dword v154, v120, s[4:5] offset:512
    global_load_dword v155, v120, s[4:5] offset:768
B_x1:
    global_load_dword v156, v121, s[4:5] offset:0
    global_load_dword v157, v121, s[4:5] offset:256
    global_load_dword v158, v121, s[4:5] offset:512
    global_load_dword v159, v121, s[4:5] offset:768
B_x2:
    global_load_dword v160, v122, s[4:5] offset:0
    global_load_dword v161, v122, s[4:5] offset:256
    global_load_dword v162, v122, s[4:5] offset:512
    global_load_dword v163, v122, s[4:5] offset:768
B_x3:
    global_load_dword v164, v123, s[4:5] offset:0
    global_load_dword v165, v123, s[4:5] offset:256
    global_load_dword v166, v123, s[4:5] offset:512
    global_load_dword v167, v123, s[4:5] offset:768
    s_cmp_le_u32 s49, 0
    s_cbranch_scc1 B_xd
    global_load_dword v152, v120, s[4:5] offset:0
    global_load_dword v153, v120, s[4:5] offset:256
    global_load_dword v154, v120, s[4:5] offset:512
    global_load_dword v155, v120, s[4:5] offset:768
    s_cmp_le_u32 s49, 1
    s_cbranch_scc1 B_xd
    global_load_dword v156, v121, s[4:5] offset:0
    global_load_dword v157, v121, s[4:5] offset:256
    global_load_dword v158, v121, s[4:5] offset:512
    global_load_dword v159, v121, s[4:5] offset:768
    s_cmp_le_u32 s49, 2
    s_cbranch_scc1 B_xd
    global_load_dword v160, v122, s[4:5] offset:0
    global_load_dword v161, v122, s[4:5] offset:256
    global_load_dword v162, v122, s[4:5] offset:512
    global_load_dword v163, v122, s[4:5] offset:768
B_xd:
    v_mov_b32 v220, v216
    v_mov_b32 v221, v217
    v_mov_b32 v222, v218
    v_mov_b32 v223, v219
    ds_read_b32 v245, v244
    v_readlane_b32 s69, v246, s44
    s_not_b32 s43, s41
    s_min_u32 s41, s69, s42
    s_add_u32 s43, s43, s41
    s_cmp_gt_u32 s39, 8
    s_cbranch_scc1 B_entB
    ds_read_b128 v[4:7], v240 offset:4096
    ds_read_b128 v[24:27], v240 offset:0
    ds_read_b128 v[28:31], v240 offset:5120
    ds_read_b128 v[48:51], v240 offset:1024
    ds_read_b128 v[52:55], v240 offset:6144
    ds_read_b128 v[72:75], v240 offset:2048
    ds_read_b128 v[96:99], v240 offset:3072
    s_waitcnt vmcnt(20) lgkmcnt(0)
    v_mfma_f32_32x32x16_bf16 v[8:23], v[224:227], v[4:7], 0
    v_mfma_f32_32x32x16_bf16 v[32:47], v[224:227], v[28:31], 0
    v_mfma_f32_32x32x16_bf16 v[56:71], v[224:227], v[52:55], 0
    v_mfma_f32_32x32x16_bf16 v[80:95], v[224:227], v[172:175], 0
    v_mfma_f32_32x32x16_bf16 v[104:119], v[224:227], v[176:179], 0
    v_mfma_f32_32x32x16_bf16 v[0:15], v[224:227], v[24:27], 0
    v_mfma_f32_32x32x16_bf16 v[24:39], v[224:227], v[48:51], 0
    v_mfma_f32_32x32x16_bf16 v[48:63], v[224:227], v[72:75], 0
    v_mfma_f32_32x32x16_bf16 v[72:87], v[224:227], v[96:99], 0
    v_mfma_f32_32x32x16_bf16 v[96:111], v[224:227], v[168:171], 0
    s_waitcnt vmcnt(16)
    v_mfma_f32_32x32x16_bf16 v[120:135], v[208:211], v[188:191], 0
    v_mfma_f32_32x32x16_bf16 v[136:151], v[208:211], v[188:191], 0
    s_mov_b64 exec, s[54:55]
    buffer_load_dwordx4 v[224:227], v241, s[12:15], s64 offen
    s_mov_b64 exec, -1
    ds_read_b64_tr_b16 v[208:209], v242 offset:48
    ds_read_b64_tr_b16 v[210:211], v243 offset:48
    s_nop 0
    s_nop 7
    s_cmp_le_u32 s39, 4
    s_cbranch_scc1 B_go
    ds_read_b128 v[32:35], v240 offset:4096
    ds_read_b128 v[56:59], v240 offset:5120
    ds_read_b128 v[80:83], v240 offset:6144
    s_branch B_go
B_entB:
    ds_read_b128 v[16:19], v240 offset:0
    ds_read_b128 v[44:47], v240 offset:4096
    ds_read_b128 v[40:43], v240 offset:1024
    ds_read_b128 v[68:71], v240 offset:5120
    ds_read_b128 v[64:67], v240 offset:2048
    ds_read_b128 v[92:95], v240 offset:6144
    ds_read_b128 v[88:91], v240 offset:3072
    s_waitcnt vmcnt(20) lgkmcnt(0)
    v_mfma_f32_32x32x16_bf16 v[0:15], v[224:227], v[16:19], 0
    v_mfma_f32_32x32x16_bf16 v[24:39], v[224:227], v[40:43], 0
    v_mfma_f32_32x32x16_bf16 v[48:63], v[224:227], v[64:67], 0
    v_mfma_f32_32x32x16_bf16 v[72:87], v[224:227], v[88:91], 0
    v_mfma_f32_32x32x16_bf16 v[96:111], v[224:227], v[168:171], 0
    v_mfma_f32_32x32x16_bf16 v[8:23], v[224:227], v[44:47], 0
    v_mfma_f32_32x32x16_bf16 v[32:47], v[224:227], v[68:71], 0
    v_mfma_f32_32x32x16_bf16 v[56:71], v[224:227], v[92:95], 0
    v_mfma_f32_32x32x16_bf16 v[80:95], v[224:227], v[172:175], 0
    v_mfma_f32_32x32x16_bf16 v[104:119], v[224:227], v[176:179], 0
    s_waitcnt vmcnt(16)
    v_mfma_f32_32x32x16_bf16 v[120:135], v[208:211], v[188:191], 0
    v_mfma_f32_32x32x16_bf16 v[136:151], v[208:211], v[188:191], 0
    s_mov_b64 exec, s[56:57]
    buffer_load_dwordx4 v[224:227], v241, s[12:15], s64 offen
    s_mov_b64 exec, -1
    ds_read_b64_tr_b16 v[208:209], v242 offset:48
    ds_read_b64_tr_b16 v[210:211], v243 offset:48
    s_nop 0
    s_nop 7
    s_cmp_le_u32 s39, 12
    s_cbranch_scc1 B_go
    ds_read_b128 v[24:27], v240 offset:0
    ds_read_b128 v[48:51], v240 offset:1024
    ds_read_b128 v[72:75], v240 offset:2048
    ds_read_b128 v[96:99], v240 offset:3072
B_go:
    s_sub_u32 s3, s39, 1
    s_and_b32 s3, s3, 7
    s_cmp_lt_u32 s3, 5
    s_cbranch_scc1 B_go1
    s_waitcnt vmcnt(0)
B_go1:
    s_cmp_lt_u32 s34, 4
    s_cbranch_scc1 B_go2
    s_setprio 2
B_go2:
    s_bitcmp1_b32 s39, 3
    s_cbranch_scc1 B_D3_0
    s_bitcmp1_b32 s39, 2
    s_cbranch_scc1 B_D2_0
    s_bitcmp1_b32 s39, 1
    s_cbranch_scc1 B_D1_0
    s_bitcmp1_b32 s39, 0
    s_cbranch_scc1 B_M1
    s_branch B_M0
B_D1_0:
    s_bitcmp1_b32 s39, 0
    s_cbranch_scc1 B_M3
    s_branch B_M2
B_D2_0:
    s_bitcmp1_b32 s39, 1
    s_cbranch_scc1 B_D1_4
    s_bitcmp1_b32 s39, 0
    s_cbranch_scc1 B_M5
    s_branch B_M4
B_D1_4:
    s_bitcmp1_b32 s39, 0
    s_cbranch_scc1 B_M7
    s_branch B_M6
B_D3_0:
    s_bitcmp1_b32 s39, 2
    s_cbranch_scc1 B_D2_8
    s_bitcmp1_b32 s39, 1
    s_cbranch_scc1 B_D1_8
    s_bitcmp1_b32 s39, 0
    s_cbranch_scc1 B_M9
    s_branch B_M8
B_D1_8:
    s_bitcmp1_b32 s39, 0
    s_cbranch_scc1 B_M11
    s_branch B_M10
B_D2_8:
    s_bitcmp1_b32 s39, 1
    s_cbranch_scc1 B_D1_12
    s_bitcmp1_b32 s39, 0
    s_cbranch_scc1 B_M13
    s_branch B_M12
B_D1_12:
    s_bitcmp1_b32 s39, 0
    s_cbranch_scc1 B_M15
    s_branch B_M14
.p2align 6
B_N0:
    s_waitcnt vmcnt(12) lgkmcnt(0)
    v_mfma_f32_32x32x16_bf16 v[0:15], v[224:227], v[24:27], 0
    s_sub_u32 s47, s47, 1
    s_cmp_eq_u32 s47, 0
    s_cselect_b32 s48, s53, 512
    s_cselect_b32 s50, 7168, 0
    s_cselect_b32 s52, 128, 0
    s_ashr_i32 s98, s48, 1
    s_ashr_i32 s62, s48, 2
    v_add_u32 v238, s62, v238
    ds_read_b32 v241, v238
    v_fmac_f32 v185, v128, v16
    v_fmac_f32 v187, v132, v40
    v_mul_f32 v243, v128, v64
    v_mfma_f32_32x32x16_bf16 v[24:39], v[224:227], v[48:51], 0
    v_fmac_f32 v191, v129, v88
    v_fmac_f32 v197, v130, v88
    v_fmac_f32 v203, v131, v88
    v_mfma_f32_32x32x16_bf16 v[48:63], v[224:227], v[72:75], 0
    v_add_u32 v206, v219, v237
    v_mfma_f32_32x32x16_bf16 v[72:87], v[224:227], v[96:99], 0
    v_fmac_f32 v189, v243, v216
    v_fmac_f32 v195, v243, v217
    v_fmac_f32 v201, v243, v218
    v_mfma_f32_32x32x16_bf16 v[96:111], v[224:227], v[168:171], 0
    v_fmac_f32 v193, v133, v112
    v_fmac_f32 v199, v134, v112
    v_fmac_f32 v205, v135, v112
    s_waitcnt lgkmcnt(0)
    v_add_u32 v241, v248, v241
    v_mfma_f32_32x32x16_bf16 v[136:151], v[208:211], v[156:159], 0
    ds_read_b64_tr_b16 v[208:209], v235 offset:96
    ds_read_b64_tr_b16 v[210:211], v232 offset:96
    ds_read_b128 v[220:223], v236 offset:32
    global_load_dword v156, v206, s[4:5] offset:0
    global_load_dword v157, v206, s[4:5] offset:256
    global_load_dword v158, v206, s[4:5] offset:512
    global_load_dword v159, v206, s[4:5] offset:768
    s_mov_b64 exec, s[54:55]
    buffer_load_dwordx4 v[224:227], v241, s[12:15], s64 offen
    s_mov_b64 exec, -1
    s_sub_u32 s43, s43, 1
    v_fmac_f32 v184, v120, v8
    v_fmac_f32 v186, v124, v32
    v_mul_f32 v242, v120, v56
    v_fmac_f32 v190, v121, v80
    v_fmac_f32 v196, v122, v80
    v_fmac_f32 v202, v123, v80
    v_fmac_f32 v188, v242, v216
    v_fmac_f32 v194, v242, v217
    v_fmac_f32 v200, v242, v218
    v_fmac_f32 v192, v125, v104
    v_fmac_f32 v198, v126, v104
    v_fmac_f32 v204, v127, v104
    s_cbranch_scc1 B_FL0
B_N1:
    v_fmac_f32 v184, v136, v9
    v_fmac_f32 v186, v140, v33
    v_mul_f32 v242, v136, v57
    v_fmac_f32 v190, v137, v81
    v_fmac_f32 v196, v138, v81
    v_fmac_f32 v202, v139, v81
    s_waitcnt vmcnt(13) lgkmcnt(0)
    v_add_u32 v206, v223, v237
    v_mfma_f32_32x32x16_bf16 v[120:135], v[208:211], v[160:163], 0
    ds_read_b64_tr_b16 v[208:209], v235 offset:144
    ds_read_b64_tr_b16 v[210:211], v232 offset:144
    ds_read_b128 v[216:219], v236 offset:64
    global_load_dword v160, v206, s[4:5] offset:0
    global_load_dword v161, v206, s[4:5] offset:256
    global_load_dword v162, v206, s[4:5] offset:512
    global_load_dword v163, v206, s[4:5] offset:768
    s_sub_u32 s43, s43, 1
    v_fmac_f32 v192, v141, v105
    v_fmac_f32 v198, v142, v105
    v_fmac_f32 v204, v143, v105
    v_fmac_f32 v188, v242, v220
    v_fmac_f32 v194, v242, v221
    v_fmac_f32 v200, v242, v222
    v_fmac_f32 v185, v144, v17
    v_fmac_f32 v187, v148, v41
    v_mul_f32 v243, v144, v65
    v_fmac_f32 v191, v145, v89
    v_fmac_f32 v197, v146, v89
    v_fmac_f32 v203, v147, v89
    v_fmac_f32 v189, v243, v220
    v_fmac_f32 v195, v243, v221
    v_fmac_f32 v201, v243, v222
    v_fmac_f32 v193, v149, v113
    v_fmac_f32 v199, v150, v113
    v_fmac_f32 v205, v151, v113
    s_cbranch_scc1 B_FL1
B_N2:
    v_fmac_f32 v184, v120, v10
    v_fmac_f32 v186, v124, v34
    v_mul_f32 v242, v120, v58
    v_fmac_f32 v190, v121, v82
    v_fmac_f32 v196, v122, v82
    v_fmac_f32 v202, v123, v82
    s_waitcnt vmcnt(13) lgkmcnt(0)
    v_add_u32 v206, v219, v237
    v_mfma_f32_32x32x16_bf16 v[136:151], v[208:211], v[164:167], 0
    ds_read_b64_tr_b16 v[208:209], v235 offset:192
    ds_read_b64_tr_b16 v[210:211], v232 offset:192
    ds_read_b128 v[220:223], v236 offset:96
    global_load_dword v164, v206, s[4:5] offset:0
    global_load_dword v165, v206, s[4:5] offset:256
    global_load_dword v166, v206, s[4:5] offset:512
    global_load_dword v167, v206, s[4:5] offset:768
    s_sub_u32 s43, s43, 1
    v_fmac_f32 v192, v125, v106
    v_fmac_f32 v198, v126, v106
    v_fmac_f32 v204, v127, v106
    v_fmac_f32 v188, v242, v216
    v_fmac_f32 v194, v242, v217
    v_fmac_f32 v200, v242, v218
    v_fmac_f32 v185, v128, v18
    v_fmac_f32 v187, v132, v42
    v_mul_f32 v243, v128, v66
    v_fmac_f32 v191, v129, v90
    v_fmac_f32 v197, v130, v90
    v_fmac_f32 v203, v131, v90
    v_fmac_f32 v189, v243, v216
    v_fmac_f32 v195, v243, v217
    v_fmac_f32 v201, v243, v218
    v_fmac_f32 v193, v133, v114
    v_fmac_f32 v199, v134, v114
    v_fmac_f32 v205, v135, v114
    s_cbranch_scc1 B_FL2
B_N3:
    v_fmac_f32 v184, v136, v11
    v_fmac_f32 v186, v140, v35
    v_mul_f32 v242, v136, v59
    v_fmac_f32 v190, v137, v83
    v_fmac_f32 v196, v138, v83
    v_fmac_f32 v202, v139, v83
    s_waitcnt vmcnt(13) lgkmcnt(0)
    v_add_u32 v206, v223, v237
    v_mfma_f32_32x32x16_bf16 v[120:135], v[208:211], v[152:155], 0
    ds_read_b64_tr_b16 v[208:209], v235 offset:240
    ds_read_b64_tr_b16 v[210:211], v232 offset:240
    ds_read_b128 v[216:219], v236 offset:128
    global_load_dword v152, v206, s[4:5] offset:0
    global_load_dword v153, v206, s[4:5] offset:256
    global_load_dword v154, v206, s[4:5] offset:512
    global_load_dword v155, v206, s[4:5] offset:768
    s_sub_u32 s43, s43, 1
    v_fmac_f32 v192, v141, v107
    v_fmac_f32 v198, v142, v107
    v_fmac_f32 v204, v143, v107
    v_fmac_f32 v188, v242, v220
    v_fmac_f32 v194, v242, v221
    v_fmac_f32 v200, v242, v222
    v_fmac_f32 v185, v144, v19
    v_fmac_f32 v187, v148, v43
    v_mul_f32 v243, v144, v67
    v_fmac_f32 v191, v145, v91
    v_fmac_f32 v197, v146, v91
    v_fmac_f32 v203, v147, v91
    v_fmac_f32 v189, v243, v220
    v_fmac_f32 v195, v243, v221
    v_fmac_f32 v201, v243, v222
    v_fmac_f32 v193, v149, v115
    v_fmac_f32 v199, v150, v115
    v_fmac_f32 v205, v151, v115
    s_cbranch_scc1 B_FL3
B_N4:
    v_fmac_f32 v184, v120, v12
    v_fmac_f32 v186, v124, v36
    v_mul_f32 v242, v120, v60
    v_fmac_f32 v190, v121, v84
    v_fmac_f32 v196, v122, v84
    v_fmac_f32 v202, v123, v84
    s_waitcnt vmcnt(13) lgkmcnt(0)
    v_add_u32 v206, v219, v237
    v_mfma_f32_32x32x16_bf16 v[136:151], v[208:211], v[156:159], 0
    ds_read_b64_tr_b16 v[208:209], v235 offset:288
    ds_read_b64_tr_b16 v[210:211], v232 offset:288
    ds_read_b128 v[220:223], v236 offset:160
    ds_read_b128 v[32:35], v240 offset:4096
    ds_read_b128 v[56:59], v240 offset:5120
    global_load_dword v156, v206, s[4:5] offset:0
    global_load_dword v157, v206, s[4:5] offset:256
    global_load_dword v158, v206, s[4:5] offset:512
    global_load_dword v159, v206, s[4:5] offset:768
    s_sub_u32 s43, s43, 1
    v_fmac_f32 v192, v125, v108
    v_fmac_f32 v198, v126, v108
    v_fmac_f32 v204, v127, v108
    v_fmac_f32 v188, v242, v216
    v_fmac_f32 v194, v242, v217
    v_fmac_f32 v200, v242, v218
    v_fmac_f32 v185, v128, v20
    v_fmac_f32 v187, v132, v44
    v_mul_f32 v243, v128, v68
    v_fmac_f32 v191, v129, v92
    v_fmac_f32 v197, v130, v92
    v_fmac_f32 v203, v131, v92
    v_fmac_f32 v189, v243, v216
    v_fmac_f32 v195, v243, v217
    v_fmac_f32 v201, v243, v218
    v_fmac_f32 v193, v133, v116
    v_fmac_f32 v199, v134, v116
    v_fmac_f32 v205, v135, v116
    s_cbranch_scc1 B_FL4
B_N5:
    v_fmac_f32 v184, v136, v13
    v_fmac_f32 v186, v140, v37
    v_mul_f32 v242, v136, v61
    v_fmac_f32 v190, v137, v85
    v_fmac_f32 v196, v138, v85
    v_fmac_f32 v202, v139, v85
    s_waitcnt vmcnt(12) lgkmcnt(0)
    v_add_u32 v206, v223, v237
    v_mfma_f32_32x32x16_bf16 v[120:135], v[208:211], v[160:163], 0
    ds_read_b64_tr_b16 v[208:209], v235 offset:336
    ds_read_b64_tr_b16 v[210:211], v232 offset:336
    ds_read_b128 v[216:219], v236 offset:192
    ds_read_b128 v[80:83], v240 offset:6144
    global_load_dword v160, v206, s[4:5] offset:0
    global_load_dword v161, v206, s[4:5] offset:256
    global_load_dword v162, v206, s[4:5] offset:512
    global_load_dword v163, v206, s[4:5] offset:768
    s_sub_u32 s43, s43, 1
    v_fmac_f32 v192, v141, v109
    v_fmac_f32 v198, v142, v109
    v_fmac_f32 v204, v143, v109
    v_fmac_f32 v188, v242, v220
    v_fmac_f32 v194, v242, v221
    v_fmac_f32 v200, v242, v222
    v_fmac_f32 v185, v144, v21
    v_fmac_f32 v187, v148, v45
    v_mul_f32 v243, v144, v69
    v_fmac_f32 v191, v145, v93
    v_fmac_f32 v197, v146, v93
    v_fmac_f32 v203, v147, v93
    v_fmac_f32 v189, v243, v220
    v_fmac_f32 v195, v243, v221
    v_fmac_f32 v201, v243, v222
    v_fmac_f32 v193, v149, v117
    v_fmac_f32 v199, v150, v117
    v_fmac_f32 v205, v151, v117
    s_cbranch_scc1 B_FL5
B_N6:
    v_fmac_f32 v184, v120, v14
    v_fmac_f32 v186, v124, v38
    v_mul_f32 v242, v120, v62
    v_fmac_f32 v190, v121, v86
    v_fmac_f32 v196, v122, v86
    v_fmac_f32 v202, v123, v86
    s_waitcnt vmcnt(12) lgkmcnt(0)
    v_add_u32 v206, v219, v237
    v_mfma_f32_32x32x16_bf16 v[136:151], v[208:211], v[164:167], 0
    ds_read_b64_tr_b16 v[208:209], v235 offset:384
    ds_read_b64_tr_b16 v[210:211], v232 offset:384
    ds_read_b128 v[220:223], v236 offset:224
    global_load_dword v164, v206, s[4:5] offset:0
    global_load_dword v165, v206, s[4:5] offset:256
    global_load_dword v166, v206, s[4:5] offset:512
    global_load_dword v167, v206, s[4:5] offset:768
    s_sub_u32 s43, s43, 1
    v_fmac_f32 v192, v125, v110
    v_fmac_f32 v198, v126, v110
    v_fmac_f32 v204, v127, v110
    v_fmac_f32 v188, v242, v216
    v_fmac_f32 v194, v242, v217
    v_fmac_f32 v200, v242, v218
    v_fmac_f32 v185, v128, v22
    v_fmac_f32 v187, v132, v46
    v_mul_f32 v243, v128, v70
    v_fmac_f32 v191, v129, v94
    v_fmac_f32 v197, v130, v94
    v_fmac_f32 v203, v131, v94
    v_fmac_f32 v189, v243, v216
    v_fmac_f32 v195, v243, v217
    v_fmac_f32 v201, v243, v218
    v_fmac_f32 v193, v133, v118
    v_fmac_f32 v199, v134, v118
    v_fmac_f32 v205, v135, v118
    s_cbranch_scc1 B_FL6
B_N7:
    v_fmac_f32 v184, v136, v15
    v_fmac_f32 v186, v140, v39
    v_mul_f32 v242, v136, v63
    v_fmac_f32 v190, v137, v87
    v_fmac_f32 v196, v138, v87
    v_fmac_f32 v202, v139, v87
    s_waitcnt vmcnt(12) lgkmcnt(0)
    v_add_u32 v206, v223, v237
    v_mfma_f32_32x32x16_bf16 v[120:135], v[208:211], v[152:155], 0
    ds_read_b64_tr_b16 v[208:209], v235 offset:432
    ds_read_b64_tr_b16 v[210:211], v232 offset:432
    ds_read_b128 v[216:219], v236 offset:256
    global_load_dword v152, v206, s[4:5] offset:0
    global_load_dword v153, v206, s[4:5] offset:256
    global_load_dword v154, v206, s[4:5] offset:512
    global_load_dword v155, v206, s[4:5] offset:768
    s_sub_u32 s43, s43, 1
    v_fmac_f32 v192, v141, v111
    v_fmac_f32 v198, v142, v111
    v_fmac_f32 v204, v143, v111
    v_fmac_f32 v188, v242, v220
    v_fmac_f32 v194, v242, v221
    v_fmac_f32 v200, v242, v222
    v_fmac_f32 v185, v144, v23
    v_fmac_f32 v187, v148, v47
    v_mul_f32 v243, v144, v71
    v_fmac_f32 v191, v145, v95
    v_fmac_f32 v197, v146, v95
    v_fmac_f32 v203, v147, v95
    v_fmac_f32 v189, v243, v220
    v_fmac_f32 v195, v243, v221
    v_fmac_f32 v201, v243, v222
    v_fmac_f32 v193, v149, v119
    v_fmac_f32 v199, v150, v119
    v_fmac_f32 v205, v151, v119
    s_cbranch_scc1 B_FL7
B_N8:
    s_waitcnt vmcnt(12) lgkmcnt(0)
    v_mfma_f32_32x32x16_bf16 v[8:23], v[224:227], v[32:35], 0
    v_fmac_f32 v184, v120, v0
    v_fmac_f32 v186, v124, v24
    v_mul_f32 v242, v120, v48
    v_mfma_f32_32x32x16_bf16 v[32:47], v[224:227], v[56:59], 0
    v_fmac_f32 v190, v121, v72
    v_fmac_f32 v196, v122, v72
    v_fmac_f32 v202, v123, v72
    v_mfma_f32_32x32x16_bf16 v[56:71], v[224:227], v[80:83], 0
    v_add_u32 v206, v219, v237
    v_mfma_f32_32x32x16_bf16 v[80:95], v[224:227], v[172:175], 0
    v_fmac_f32 v188, v242, v216
    v_fmac_f32 v194, v242, v217
    v_fmac_f32 v200, v242, v218
    v_mfma_f32_32x32x16_bf16 v[104:119], v[224:227], v[176:179], 0
    v_fmac_f32 v192, v125, v96
    v_fmac_f32 v198, v126, v96
    v_fmac_f32 v204, v127, v96
    v_mfma_f32_32x32x16_bf16 v[136:151], v[208:211], v[156:159], 0
    ds_read_b64_tr_b16 v[208:209], v235 offset:480
    ds_read_b64_tr_b16 v[210:211], v232 offset:480
    ds_read_b128 v[220:223], v236 offset:288
    global_load_dword v156, v206, s[4:5] offset:0
    global_load_dword v157, v206, s[4:5] offset:256
    global_load_dword v158, v206, s[4:5] offset:512
    global_load_dword v159, v206, s[4:5] offset:768
    s_mov_b64 exec, s[56:57]
    buffer_load_dwordx4 v[224:227], v241, s[12:15], s64 offen
    s_mov_b64 exec, -1
    s_sub_u32 s43, s43, 1
    v_fmac_f32 v185, v128, v8
    v_fmac_f32 v187, v132, v32
    v_mul_f32 v243, v128, v56
    v_fmac_f32 v191, v129, v80
    v_fmac_f32 v197, v130, v80
    v_fmac_f32 v203, v131, v80
    v_fmac_f32 v189, v243, v216
    v_fmac_f32 v195, v243, v217
    v_fmac_f32 v201, v243, v218
    v_fmac_f32 v193, v133, v104
    v_fmac_f32 v199, v134, v104
    v_fmac_f32 v205, v135, v104
    s_cbranch_scc1 B_FL8
B_N9:
    v_fmac_f32 v184, v136, v1
    v_fmac_f32 v186, v140, v25
    v_mul_f32 v242, v136, v49
    v_fmac_f32 v190, v137, v73
    v_fmac_f32 v196, v138, v73
    v_fmac_f32 v202, v139, v73
    s_waitcnt vmcnt(13) lgkmcnt(0)
    v_add_u32 v206, v223, v237
    v_mfma_f32_32x32x16_bf16 v[120:135], v[208:211], v[160:163], 0
    ds_read_b64_tr_b16 v[208:209], v235 offset:528
    ds_read_b64_tr_b16 v[210:211], v232 offset:528
    ds_read_b128 v[216:219], v236 offset:320
    global_load_dword v160, v206, s[4:5] offset:0
    global_load_dword v161, v206, s[4:5] offset:256
    global_load_dword v162, v206, s[4:5] offset:512
    global_load_dword v163, v206, s[4:5] offset:768
    s_sub_u32 s43, s43, 1
    v_fmac_f32 v192, v141, v97
    v_fmac_f32 v198, v142, v97
    v_fmac_f32 v204, v143, v97
    v_fmac_f32 v188, v242, v220
    v_fmac_f32 v194, v242, v221
    v_fmac_f32 v200, v242, v222
    v_fmac_f32 v185, v144, v9
    v_fmac_f32 v187, v148, v33
    v_mul_f32 v243, v144, v57
    v_fmac_f32 v191, v145, v81
    v_fmac_f32 v197, v146, v81
    v_fmac_f32 v203, v147, v81
    v_fmac_f32 v189, v243, v220
    v_fmac_f32 v195, v243, v221
    v_fmac_f32 v201, v243, v222
    v_fmac_f32 v193, v149, v105
    v_fmac_f32 v199, v150, v105
    v_fmac_f32 v205, v151, v105
    s_cbranch_scc1 B_FL9
B_N10:
    v_fmac_f32 v184, v120, v2
    v_fmac_f32 v186, v124, v26
    v_mul_f32 v242, v120, v50
    v_fmac_f32 v190, v121, v74
    v_fmac_f32 v196, v122, v74
    v_fmac_f32 v202, v123, v74
    s_waitcnt vmcnt(13) lgkmcnt(0)
    v_add_u32 v206, v219, v237
    v_mfma_f32_32x32x16_bf16 v[136:151], v[208:211], v[164:167], 0
    ds_read_b64_tr_b16 v[208:209], v235 offset:576
    ds_read_b64_tr_b16 v[210:211], v232 offset:576
    ds_read_b128 v[220:223], v236 offset:352
    global_load_dword v164, v206, s[4:5] offset:0
    global_load_dword v165, v206, s[4:5] offset:256
    global_load_dword v166, v206, s[4:5] offset:512
    global_load_dword v167, v206, s[4:5] offset:768
    s_sub_u32 s43, s43, 1
    v_fmac_f32 v192, v125, v98
    v_fmac_f32 v198, v126, v98
    v_fmac_f32 v204, v127, v98
    v_fmac_f32 v188, v242, v216
    v_fmac_f32 v194, v242, v217
    v_fmac_f32 v200, v242, v218
    v_fmac_f32 v185, v128, v10
    v_fmac_f32 v187, v132, v34
    v_mul_f32 v243, v128, v58
    v_fmac_f32 v191, v129, v82
    v_fmac_f32 v197, v130, v82
    v_fmac_f32 v203, v131, v82
    v_fmac_f32 v189, v243, v216
    v_fmac_f32 v195, v243, v217
    v_fmac_f32 v201, v243, v218
    v_fmac_f32 v193, v133, v106
    v_fmac_f32 v199, v134, v106
    v_fmac_f32 v205, v135, v106
    s_cbranch_scc1 B_FL10
B_N11:
    v_fmac_f32 v184, v136, v3
    v_fmac_f32 v186, v140, v27
    v_mul_f32 v242, v136, v51
    v_fmac_f32 v190, v137, v75
    v_fmac_f32 v196, v138, v75
    v_fmac_f32 v202, v139, v75
    s_waitcnt vmcnt(13) lgkmcnt(0)
    v_add_u32 v237, s52, v237
    v_add_u32 v206, v223, v237
    v_mfma_f32_32x32x16_bf16 v[120:135], v[208:211], v[152:155], 0
    ds_read_b64_tr_b16 v[208:209], v235 offset:624
    ds_read_b64_tr_b16 v[210:211], v232 offset:624
    ds_read_b128 v[216:219], v236 offset:384
    global_load_dword v152, v206, s[4:5] offset:0
    global_load_dword v153, v206, s[4:5] offset:256
    global_load_dword v154, v206, s[4:5] offset:512
    global_load_dword v155, v206, s[4:5] offset:768
    s_sub_u32 s43, s43, 1
    v_fmac_f32 v192, v141, v99
    v_fmac_f32 v198, v142, v99
    v_fmac_f32 v204, v143, v99
    v_fmac_f32 v188, v242, v220
    v_fmac_f32 v194, v242, v221
    v_fmac_f32 v200, v242, v222
    v_fmac_f32 v185, v144, v11
    v_fmac_f32 v187, v148, v35
    v_mul_f32 v243, v144, v59
    v_fmac_f32 v191, v145, v83
    v_fmac_f32 v197, v146, v83
    v_fmac_f32 v203, v147, v83
    v_fmac_f32 v189, v243, v220
    v_fmac_f32 v195, v243, v221
    v_fmac_f32 v201, v243, v222
    v_fmac_f32 v193, v149, v107
    v_fmac_f32 v199, v150, v107
    v_fmac_f32 v205, v151, v107
    s_cbranch_scc1 B_FL11
B_N12:
    v_fmac_f32 v184, v120, v4
    v_fmac_f32 v186, v124, v28
    v_mul_f32 v242, v120, v52
    v_fmac_f32 v190, v121, v76
    v_fmac_f32 v196, v122, v76
    v_fmac_f32 v202, v123, v76
    s_waitcnt vmcnt(13) lgkmcnt(0)
    v_add_u32 v206, v219, v237
    v_add_u32 v240, s50, v240
    v_mfma_f32_32x32x16_bf16 v[136:151], v[208:211], v[156:159], 0
    ds_read_b64_tr_b16 v[208:209], v235 offset:672
    ds_read_b64_tr_b16 v[210:211], v232 offset:672
    ds_read_b128 v[220:223], v236 offset:416
    ds_read_b128 v[24:27], v240 offset:0
    ds_read_b128 v[48:51], v240 offset:1024
    global_load_dword v156, v206, s[4:5] offset:0
    global_load_dword v157, v206, s[4:5] offset:256
    global_load_dword v158, v206, s[4:5] offset:512
    global_load_dword v159, v206, s[4:5] offset:768
    s_sub_u32 s43, s43, 1
    v_fmac_f32 v192, v125, v100
    v_fmac_f32 v198, v126, v100
    v_fmac_f32 v204, v127, v100
    v_fmac_f32 v188, v242, v216
    v_fmac_f32 v194, v242, v217
    v_fmac_f32 v200, v242, v218
    v_fmac_f32 v185, v128, v12
    v_fmac_f32 v187, v132, v36
    v_mul_f32 v243, v128, v60
    v_fmac_f32 v191, v129, v84
    v_fmac_f32 v197, v130, v84
    v_fmac_f32 v203, v131, v84
    v_fmac_f32 v189, v243, v216
    v_fmac_f32 v195, v243, v217
    v_fmac_f32 v201, v243, v218
    v_fmac_f32 v193, v133, v108
    v_fmac_f32 v199, v134, v108
    v_fmac_f32 v205, v135, v108
    s_cbranch_scc1 B_FL12
B_N13:
    v_fmac_f32 v184, v136, v5
    v_fmac_f32 v186, v140, v29
    v_mul_f32 v242, v136, v53
    v_fmac_f32 v190, v137, v77
    v_fmac_f32 v196, v138, v77
    v_fmac_f32 v202, v139, v77
    s_waitcnt vmcnt(12) lgkmcnt(0)
    v_add_u32 v206, v223, v237
    v_mfma_f32_32x32x16_bf16 v[120:135], v[208:211], v[160:163], 0
    ds_read_b64_tr_b16 v[208:209], v235 offset:720
    ds_read_b64_tr_b16 v[210:211], v232 offset:720
    ds_read_b128 v[216:219], v236 offset:448
    ds_read_b128 v[72:75], v240 offset:2048
    ds_read_b128 v[96:99], v240 offset:3072
    global_load_dword v160, v206, s[4:5] offset:0
    global_load_dword v161, v206, s[4:5] offset:256
    global_load_dword v162, v206, s[4:5] offset:512
    global_load_dword v163, v206, s[4:5] offset:768
    s_sub_u32 s43, s43, 1
    v_fmac_f32 v192, v141, v101
    v_fmac_f32 v198, v142, v101
    v_fmac_f32 v204, v143, v101
    v_fmac_f32 v188, v242, v220
    v_fmac_f32 v194, v242, v221
    v_fmac_f32 v200, v242, v222
    v_fmac_f32 v185, v144, v13
    v_fmac_f32 v187, v148, v37
    v_mul_f32 v243, v144, v61
    v_fmac_f32 v191, v145, v85
    v_fmac_f32 v197, v146, v85
    v_fmac_f32 v203, v147, v85
    v_fmac_f32 v189, v243, v220
    v_fmac_f32 v195, v243, v221
    v_fmac_f32 v201, v243, v222
    v_fmac_f32 v193, v149, v109
    v_fmac_f32 v199, v150, v109
    v_fmac_f32 v205, v151, v109
    s_cbranch_scc1 B_FL13
B_N14:
    v_fmac_f32 v184, v120, v6
    v_fmac_f32 v186, v124, v30
    v_mul_f32 v242, v120, v54
    v_fmac_f32 v190, v121, v78
    v_fmac_f32 v196, v122, v78
    v_fmac_f32 v202, v123, v78
    s_waitcnt vmcnt(12) lgkmcnt(0)
    v_add_u32 v206, v219, v237
    v_mad_i32_i24 v235, v239, s98, v235
    v_mad_i32_i24 v232, v233, s98, v232
    v_mfma_f32_32x32x16_bf16 v[136:151], v[208:211], v[164:167], 0
    ds_read_b64_tr_b16 v[208:209], v235 offset:0
    ds_read_b64_tr_b16 v[210:211], v232 offset:0
    ds_read_b128 v[220:223], v236 offset:480
    global_load_dword v164, v206, s[4:5] offset:0
    global_load_dword v165, v206, s[4:5] offset:256
    global_load_dword v166, v206, s[4:5] offset:512
    global_load_dword v167, v206, s[4:5] offset:768
    s_sub_u32 s43, s43, 1
    v_fmac_f32 v192, v125, v102
    v_fmac_f32 v198, v126, v102
    v_fmac_f32 v204, v127, v102
    v_fmac_f32 v188, v242, v216
    v_fmac_f32 v194, v242, v217
    v_fmac_f32 v200, v242, v218
    v_fmac_f32 v185, v128, v14
    v_fmac_f32 v187, v132, v38
    v_mul_f32 v243, v128, v62
    v_fmac_f32 v191, v129, v86
    v_fmac_f32 v197, v130, v86
    v_fmac_f32 v203, v131, v86
    v_fmac_f32 v189, v243, v216
    v_fmac_f32 v195, v243, v217
    v_fmac_f32 v201, v243, v218
    v_fmac_f32 v193, v133, v110
    v_fmac_f32 v199, v134, v110
    v_fmac_f32 v205, v135, v110
    s_cbranch_scc1 B_FL14
B_N15:
    v_fmac_f32 v184, v136, v7
    v_fmac_f32 v186, v140, v31
    v_mul_f32 v242, v136, v55
    v_fmac_f32 v190, v137, v79
    v_fmac_f32 v196, v138, v79
    v_fmac_f32 v202, v139, v79
    s_waitcnt vmcnt(12) lgkmcnt(0)
    v_add_u32 v206, v223, v237
    v_add_u32 v236, s48, v236
    v_mfma_f32_32x32x16_bf16 v[120:135], v[208:211], v[152:155], 0
    ds_read_b64_tr_b16 v[208:209], v235 offset:48
    ds_read_b64_tr_b16 v[210:211], v232 offset:48
    ds_read_b128 v[216:219], v236 offset:0
    global_load_dword v152, v206, s[4:5] offset:0
    global_load_dword v153, v206, s[4:5] offset:256
    global_load_dword v154, v206, s[4:5] offset:512
    global_load_dword v155, v206, s[4:5] offset:768
    s_sub_u32 s43, s43, 1
    v_fmac_f32 v192, v141, v103
    v_fmac_f32 v198, v142, v103
    v_fmac_f32 v204, v143, v103
    v_fmac_f32 v188, v242, v220
    v_fmac_f32 v194, v242, v221
    v_fmac_f32 v200, v242, v222
    v_fmac_f32 v185, v144, v15
    v_fmac_f32 v187, v148, v39
    v_mul_f32 v243, v144, v63
    v_fmac_f32 v191, v145, v87
    v_fmac_f32 v197, v146, v87
    v_fmac_f32 v203, v147, v87
    v_fmac_f32 v189, v243, v220
    v_fmac_f32 v195, v243, v221
    v_fmac_f32 v201, v243, v222
    v_fmac_f32 v193, v149, v111
    v_fmac_f32 v199, v150, v111
    v_fmac_f32 v205, v151, v111
    s_cbranch_scc1 B_FL15
    s_branch B_N0
B_M0:
    s_waitcnt vmcnt(12) lgkmcnt(0)
    v_mfma_f32_32x32x16_bf16 v[0:15], v[224:227], v[24:27], 0
    s_sub_u32 s47, s47, 1
    s_cmp_eq_u32 s47, 0
    s_cselect_b32 s48, s53, 512
    s_cselect_b32 s50, 7168, 0
    s_cselect_b32 s52, 128, 0
    s_ashr_i32 s98, s48, 1
    s_ashr_i32 s62, s48, 2
    v_add_u32 v238, s62, v238
    ds_read_b32 v241, v238
    v_mul_f32 v185, v128, v16
    v_mul_f32 v187, v132, v40
    v_mul_f32 v243, v128, v64
    v_mfma_f32_32x32x16_bf16 v[24:39], v[224:227], v[48:51], 0
    v_mul_f32 v191, v129, v88
    v_mul_f32 v197, v130, v88
    v_mul_f32 v203, v131, v88
    v_mfma_f32_32x32x16_bf16 v[48:63], v[224:227], v[72:75], 0
    v_add_u32 v206, v219, v237
    v_mfma_f32_32x32x16_bf16 v[72:87], v[224:227], v[96:99], 0
    v_mul_f32 v189, v243, v216
    v_mul_f32 v195, v243, v217
    v_mul_f32 v201, v243, v218
    v_mfma_f32_32x32x16_bf16 v[96:111], v[224:227], v[168:171], 0
    v_mul_f32 v193, v133, v112
    v_mul_f32 v199, v134, v112
    v_mul_f32 v205, v135, v112
    s_waitcnt lgkmcnt(0)
    v_add_u32 v241, v248, v241
    v_mfma_f32_32x32x16_bf16 v[136:151], v[208:211], v[156:159], 0
    ds_read_b64_tr_b16 v[208:209], v235 offset:96
    ds_read_b64_tr_b16 v[210:211], v232 offset:96
    ds_read_b128 v[220:223], v236 offset:32
    global_load_dword v156, v206, s[4:5] offset:0
    global_load_dword v157, v206, s[4:5] offset:256
    global_load_dword v158, v206, s[4:5] offset:512
    global_load_dword v159, v206, s[4:5] offset:768
    s_mov_b64 exec, s[54:55]
    buffer_load_dwordx4 v[224:227], v241, s[12:15], s64 offen
    s_mov_b64 exec, -1
    s_sub_u32 s43, s43, 1
    v_mul_f32 v184, v120, v8
    v_mul_f32 v186, v124, v32
    v_mul_f32 v242, v120, v56
    v_mul_f32 v190, v121, v80
    v_mul_f32 v196, v122, v80
    v_mul_f32 v202, v123, v80
    v_mul_f32 v188, v242, v216
    v_mul_f32 v194, v242, v217
    v_mul_f32 v200, v242, v218
    v_mul_f32 v192, v125, v104
    v_mul_f32 v198, v126, v104
    v_mul_f32 v204, v127, v104
    s_cbranch_scc0 B_N1
B_FL0:
    v_add_u32 v252, v245, v247
    s_cmp_ge_u32 s41, s63
    s_cbranch_scc1 B_FC0
B_FP0:
    v_cvt_pk_bf16_f32 v184, v184, v185
    v_cvt_pk_bf16_f32 v186, v186, v187
    v_cvt_pk_bf16_f32 v188, v188, v189
    v_cvt_pk_bf16_f32 v190, v190, v191
    v_cvt_pk_bf16_f32 v192, v192, v193
    v_cvt_pk_bf16_f32 v194, v194, v195
    v_cvt_pk_bf16_f32 v196, v196, v197
    v_cvt_pk_bf16_f32 v198, v198, v199
    v_cvt_pk_bf16_f32 v200, v200, v201
    v_cvt_pk_bf16_f32 v202, v202, v203
    v_cvt_pk_bf16_f32 v204, v204, v205
    v_add_u32 v244, 8, v244
    s_add_u32 s44, s44, 2
    s_cmp_eq_u32 s41, s42
    ds_write2st64_b32 v252, v184, v186 offset0:0 offset1:1
    ds_write2st64_b32 v252, v188, v190 offset0:2 offset1:3
    ds_write2st64_b32 v252, v192, v194 offset0:4 offset1:5
    ds_write2st64_b32 v252, v196, v198 offset0:6 offset1:7
    ds_write2st64_b32 v252, v200, v202 offset0:8 offset1:9
    ds_write_b32 v252, v204 offset:2560
    ds_write_b32 v253, v247
    s_cbranch_scc1 B_exit
    ds_read_b32 v245, v244
    v_readlane_b32 s69, v246, s44
    s_not_b32 s43, s41
    s_min_u32 s41, s69, s42
    s_add_u32 s43, s43, s41
B_M1:
    v_mul_f32 v184, v136, v9
    v_mul_f32 v186, v140, v33
    v_mul_f32 v242, v136, v57
    v_mul_f32 v190, v137, v81
    v_mul_f32 v196, v138, v81
    v_mul_f32 v202, v139, v81
    s_waitcnt vmcnt(13) lgkmcnt(0)
    v_add_u32 v206, v223, v237
    v_mfma_f32_32x32x16_bf16 v[120:135], v[208:211], v[160:163], 0
    ds_read_b64_tr_b16 v[208:209], v235 offset:144
    ds_read_b64_tr_b16 v[210:211], v232 offset:144
    ds_read_b128 v[216:219], v236 offset:64
    global_load_dword v160, v206, s[4:5] offset:0
    global_load_dword v161, v206, s[4:5] offset:256
    global_load_dword v162, v206, s[4:5] offset:512
    global_load_dword v163, v206, s[4:5] offset:768
    s_sub_u32 s43, s43, 1
    v_mul_f32 v192, v141, v105
    v_mul_f32 v198, v142, v105
    v_mul_f32 v204, v143, v105
    v_mul_f32 v188, v242, v220
    v_mul_f32 v194, v242, v221
    v_mul_f32 v200, v242, v222
    v_mul_f32 v185, v144, v17
    v_mul_f32 v187, v148, v41
    v_mul_f32 v243, v144, v65
    v_mul_f32 v191, v145, v89
    v_mul_f32 v197, v146, v89
    v_mul_f32 v203, v147, v89
    v_mul_f32 v189, v243, v220
    v_mul_f32 v195, v243, v221
    v_mul_f32 v201, v243, v222
    v_mul_f32 v193, v149, v113
    v_mul_f32 v199, v150, v113
    v_mul_f32 v205, v151, v113
    s_cbranch_scc0 B_N2
B_FL1:
    v_add_u32 v252, v245, v247
    s_cmp_ge_u32 s41, s63
    s_cbranch_scc1 B_FC1
B_FP1:
    v_cvt_pk_bf16_f32 v184, v184, v185
    v_cvt_pk_bf16_f32 v186, v186, v187
    v_cvt_pk_bf16_f32 v188, v188, v189
    v_cvt_pk_bf16_f32 v190, v190, v191
    v_cvt_pk_bf16_f32 v192, v192, v193
    v_cvt_pk_bf16_f32 v194, v194, v195
    v_cvt_pk_bf16_f32 v196, v196, v197
    v_cvt_pk_bf16_f32 v198, v198, v199
    v_cvt_pk_bf16_f32 v200, v200, v201
    v_cvt_pk_bf16_f32 v202, v202, v203
    v_cvt_pk_bf16_f32 v204, v204, v205
    v_add_u32 v244, 8, v244
    s_add_u32 s44, s44, 2
    s_cmp_eq_u32 s41, s42
    ds_write2st64_b32 v252, v184, v186 offset0:0 offset1:1
    ds_write2st64_b32 v252, v188, v190 offset0:2 offset1:3
    ds_write2st64_b32 v252, v192, v194 offset0:4 offset1:5
    ds_write2st64_b32 v252, v196, v198 offset0:6 offset1:7
    ds_write2st64_b32 v252, v200, v202 offset0:8 offset1:9
    ds_write_b32 v252, v204 offset:2560
    ds_write_b32 v253, v247
    s_cbranch_scc1 B_exit
    ds_read_b32 v245, v244
    v_readlane_b32 s69, v246, s44
    s_not_b32 s43, s41
    s_min_u32 s41, s69, s42
    s_add_u32 s43, s43, s41
B_M2:
    v_mul_f32 v184, v120, v10
    v_mul_f32 v186, v124, v34
    v_mul_f32 v242, v120, v58
    v_mul_f32 v190, v121, v82
    v_mul_f32 v196, v122, v82
    v_mul_f32 v202, v123, v82
    s_waitcnt vmcnt(13) lgkmcnt(0)
    v_add_u32 v206, v219, v237
    v_mfma_f32_32x32x16_bf16 v[136:151], v[208:211], v[164:167], 0
    ds_read_b64_tr_b16 v[208:209], v235 offset:192
    ds_read_b64_tr_b16 v[210:211], v232 offset:192
    ds_read_b128 v[220:223], v236 offset:96
    global_load_dword v164, v206, s[4:5] offset:0
    global_load_dword v165, v206, s[4:5] offset:256
    global_load_dword v166, v206, s[4:5] offset:512
    global_load_dword v167, v206, s[4:5] offset:768
    s_sub_u32 s43, s43, 1
    v_mul_f32 v192, v125, v106
    v_mul_f32 v198, v126, v106
    v_mul_f32 v204, v127, v106
    v_mul_f32 v188, v242, v216
    v_mul_f32 v194, v242, v217
    v_mul_f32 v200, v242, v218
    v_mul_f32 v185, v128, v18
    v_mul_f32 v187, v132, v42
    v_mul_f32 v243, v128, v66
    v_mul_f32 v191, v129, v90
    v_mul_f32 v197, v130, v90
    v_mul_f32 v203, v131, v90
    v_mul_f32 v189, v243, v216
    v_mul_f32 v195, v243, v217
    v_mul_f32 v201, v243, v218
    v_mul_f32 v193, v133, v114
    v_mul_f32 v199, v134, v114
    v_mul_f32 v205, v135, v114
    s_cbranch_scc0 B_N3
B_FL2:
    v_add_u32 v252, v245, v247
    s_cmp_ge_u32 s41, s63
    s_cbranch_scc1 B_FC2
B_FP2:
    v_cvt_pk_bf16_f32 v184, v184, v185
    v_cvt_pk_bf16_f32 v186, v186, v187
    v_cvt_pk_bf16_f32 v188, v188, v189
    v_cvt_pk_bf16_f32 v190, v190, v191
    v_cvt_pk_bf16_f32 v192, v192, v193
    v_cvt_pk_bf16_f32 v194, v194, v195
    v_cvt_pk_bf16_f32 v196, v196, v197
    v_cvt_pk_bf16_f32 v198, v198, v199
    v_cvt_pk_bf16_f32 v200, v200, v201
    v_cvt_pk_bf16_f32 v202, v202, v203
    v_cvt_pk_bf16_f32 v204, v204, v205
    v_add_u32 v244, 8, v244
    s_add_u32 s44, s44, 2
    s_cmp_eq_u32 s41, s42
    ds_write2st64_b32 v252, v184, v186 offset0:0 offset1:1
    ds_write2st64_b32 v252, v188, v190 offset0:2 offset1:3
    ds_write2st64_b32 v252, v192, v194 offset0:4 offset1:5
    ds_write2st64_b32 v252, v196, v198 offset0:6 offset1:7
    ds_write2st64_b32 v252, v200, v202 offset0:8 offset1:9
    ds_write_b32 v252, v204 offset:2560
    ds_write_b32 v253, v247
    s_cbranch_scc1 B_exit
    ds_read_b32 v245, v244
    v_readlane_b32 s69, v246, s44
    s_not_b32 s43, s41
    s_min_u32 s41, s69, s42
    s_add_u32 s43, s43, s41
B_M3:
    v_mul_f32 v184, v136, v11
    v_mul_f32 v186, v140, v35
    v_mul_f32 v242, v136, v59
    v_mul_f32 v190, v137, v83
    v_mul_f32 v196, v138, v83
    v_mul_f32 v202, v139, v83
    s_waitcnt vmcnt(13) lgkmcnt(0)
    v_add_u32 v206, v223, v237
    v_mfma_f32_32x32x16_bf16 v[120:135], v[208:211], v[152:155], 0
    ds_read_b64_tr_b16 v[208:209], v235 offset:240
    ds_read_b64_tr_b16 v[210:211], v232 offset:240
    ds_read_b128 v[216:219], v236 offset:128
    global_load_dword v152, v206, s[4:5] offset:0
    global_load_dword v153, v206, s[4:5] offset:256
    global_load_dword v154, v206, s[4:5] offset:512
    global_load_dword v155, v206, s[4:5] offset:768
    s_sub_u32 s43, s43, 1
    v_mul_f32 v192, v141, v107
    v_mul_f32 v198, v142, v107
    v_mul_f32 v204, v143, v107
    v_mul_f32 v188, v242, v220
    v_mul_f32 v194, v242, v221
    v_mul_f32 v200, v242, v222
    v_mul_f32 v185, v144, v19
    v_mul_f32 v187, v148, v43
    v_mul_f32 v243, v144, v67
    v_mul_f32 v191, v145, v91
    v_mul_f32 v197, v146, v91
    v_mul_f32 v203, v147, v91
    v_mul_f32 v189, v243, v220
    v_mul_f32 v195, v243, v221
    v_mul_f32 v201, v243, v222
    v_mul_f32 v193, v149, v115
    v_mul_f32 v199, v150, v115
    v_mul_f32 v205, v151, v115
    s_cbranch_scc0 B_N4
B_FL3:
    v_add_u32 v252, v245, v247
    s_cmp_ge_u32 s41, s63
    s_cbranch_scc1 B_FC3
B_FP3:
    v_cvt_pk_bf16_f32 v184, v184, v185
    v_cvt_pk_bf16_f32 v186, v186, v187
    v_cvt_pk_bf16_f32 v188, v188, v189
    v_cvt_pk_bf16_f32 v190, v190, v191
    v_cvt_pk_bf16_f32 v192, v192, v193
    v_cvt_pk_bf16_f32 v194, v194, v195
    v_cvt_pk_bf16_f32 v196, v196, v197
    v_cvt_pk_bf16_f32 v198, v198, v199
    v_cvt_pk_bf16_f32 v200, v200, v201
    v_cvt_pk_bf16_f32 v202, v202, v203
    v_cvt_pk_bf16_f32 v204, v204, v205
    v_add_u32 v244, 8, v244
    s_add_u32 s44, s44, 2
    s_cmp_eq_u32 s41, s42
    ds_write2st64_b32 v252, v184, v186 offset0:0 offset1:1
    ds_write2st64_b32 v252, v188, v190 offset0:2 offset1:3
    ds_write2st64_b32 v252, v192, v194 offset0:4 offset1:5
    ds_write2st64_b32 v252, v196, v198 offset0:6 offset1:7
    ds_write2st64_b32 v252, v200, v202 offset0:8 offset1:9
    ds_write_b32 v252, v204 offset:2560
    ds_write_b32 v253, v247
    s_cbranch_scc1 B_exit
    ds_read_b32 v245, v244
    v_readlane_b32 s69, v246, s44
    s_not_b32 s43, s41
    s_min_u32 s41, s69, s42
    s_add_u32 s43, s43, s41
B_M4:
    v_mul_f32 v184, v120, v12
    v_mul_f32 v186, v124, v36
    v_mul_f32 v242, v120, v60
    v_mul_f32 v190, v121, v84
    v_mul_f32 v196, v122, v84
    v_mul_f32 v202, v123, v84
    s_waitcnt vmcnt(13) lgkmcnt(0)
    v_add_u32 v206, v219, v237
    v_mfma_f32_32x32x16_bf16 v[136:151], v[208:211], v[156:159], 0
    ds_read_b64_tr_b16 v[208:209], v235 offset:288
    ds_read_b64_tr_b16 v[210:211], v232 offset:288
    ds_read_b128 v[220:223], v236 offset:160
    ds_read_b128 v[32:35], v240 offset:4096
    ds_read_b128 v[56:59], v240 offset:5120
    global_load_dword v156, v206, s[4:5] offset:0
    global_load_dword v157, v206, s[4:5] offset:256
    global_load_dword v158, v206, s[4:5] offset:512
    global_load_dword v159, v206, s[4:5] offset:768
    s_sub_u32 s43, s43, 1
    v_mul_f32 v192, v125, v108
    v_mul_f32 v198, v126, v108
    v_mul_f32 v204, v127, v108
    v_mul_f32 v188, v242, v216
    v_mul_f32 v194, v242, v217
    v_mul_f32 v200, v242, v218
    v_mul_f32 v185, v128, v20
    v_mul_f32 v187, v132, v44
    v_mul_f32 v243, v128, v68
    v_mul_f32 v191, v129, v92
    v_mul_f32 v197, v130, v92
    v_mul_f32 v203, v131, v92
    v_mul_f32 v189, v243, v216
    v_mul_f32 v195, v243, v217
    v_mul_f32 v201, v243, v218
    v_mul_f32 v193, v133, v116
    v_mul_f32 v199, v134, v116
    v_mul_f32 v205, v135, v116
    s_cbranch_scc0 B_N5
B_FL4:
    v_add_u32 v252, v245, v247
    s_cmp_ge_u32 s41, s63
    s_cbranch_scc1 B_FC4
B_FP4:
    v_cvt_pk_bf16_f32 v184, v184, v185
    v_cvt_pk_bf16_f32 v186, v186, v187
    v_cvt_pk_bf16_f32 v188, v188, v189
    v_cvt_pk_bf16_f32 v190, v190, v191
    v_cvt_pk_bf16_f32 v192, v192, v193
    v_cvt_pk_bf16_f32 v194, v194, v195
    v_cvt_pk_bf16_f32 v196, v196, v197
    v_cvt_pk_bf16_f32 v198, v198, v199
    v_cvt_pk_bf16_f32 v200, v200, v201
    v_cvt_pk_bf16_f32 v202, v202, v203
    v_cvt_pk_bf16_f32 v204, v204, v205
    v_add_u32 v244, 8, v244
    s_add_u32 s44, s44, 2
    s_cmp_eq_u32 s41, s42
    ds_write2st64_b32 v252, v184, v186 offset0:0 offset1:1
    ds_write2st64_b32 v252, v188, v190 offset0:2 offset1:3
    ds_write2st64_b32 v252, v192, v194 offset0:4 offset1:5
    ds_write2st64_b32 v252, v196, v198 offset0:6 offset1:7
    ds_write2st64_b32 v252, v200, v202 offset0:8 offset1:9
    ds_write_b32 v252, v204 offset:2560
    ds_write_b32 v253, v247
    s_cbranch_scc1 B_exit
    ds_read_b32 v245, v244
    v_readlane_b32 s69, v246, s44
    s_not_b32 s43, s41
    s_min_u32 s41, s69, s42
    s_add_u32 s43, s43, s41
B_M5:
    v_mul_f32 v184, v136, v13
    v_mul_f32 v186, v140, v37
    v_mul_f32 v242, v136, v61
    v_mul_f32 v190, v137, v85
    v_mul_f32 v196, v138, v85
    v_mul_f32 v202, v139, v85
    s_waitcnt vmcnt(12) lgkmcnt(0)
    v_add_u32 v206, v223, v237
    v_mfma_f32_32x32x16_bf16 v[120:135], v[208:211], v[160:163], 0
    ds_read_b64_tr_b16 v[208:209], v235 offset:336
    ds_read_b64_tr_b16 v[210:211], v232 offset:336
    ds_read_b128 v[216:219], v236 offset:192
    ds_read_b128 v[80:83], v240 offset:6144
    global_load_dword v160, v206, s[4:5] offset:0
    global_load_dword v161, v206, s[4:5] offset:256
    global_load_dword v162, v206, s[4:5] offset:512
    global_load_dword v163, v206, s[4:5] offset:768
    s_sub_u32 s43, s43, 1
    v_mul_f32 v192, v141, v109
    v_mul_f32 v198, v142, v109
    v_mul_f32 v204, v143, v109
    v_mul_f32 v188, v242, v220
    v_mul_f32 v194, v242, v221
    v_mul_f32 v200, v242, v222
    v_mul_f32 v185, v144, v21
    v_mul_f32 v187, v148, v45
    v_mul_f32 v243, v144, v69
    v_mul_f32 v191, v145, v93
    v_mul_f32 v197, v146, v93
    v_mul_f32 v203, v147, v93
    v_mul_f32 v189, v243, v220
    v_mul_f32 v195, v243, v221
    v_mul_f32 v201, v243, v222
    v_mul_f32 v193, v149, v117
    v_mul_f32 v199, v150, v117
    v_mul_f32 v205, v151, v117
    s_cbranch_scc0 B_N6
B_FL5:
    v_add_u32 v252, v245, v247
    s_cmp_ge_u32 s41, s63
    s_cbranch_scc1 B_FC5
B_FP5:
    v_cvt_pk_bf16_f32 v184, v184, v185
    v_cvt_pk_bf16_f32 v186, v186, v187
    v_cvt_pk_bf16_f32 v188, v188, v189
    v_cvt_pk_bf16_f32 v190, v190, v191
    v_cvt_pk_bf16_f32 v192, v192, v193
    v_cvt_pk_bf16_f32 v194, v194, v195
    v_cvt_pk_bf16_f32 v196, v196, v197
    v_cvt_pk_bf16_f32 v198, v198, v199
    v_cvt_pk_bf16_f32 v200, v200, v201
    v_cvt_pk_bf16_f32 v202, v202, v203
    v_cvt_pk_bf16_f32 v204, v204, v205
    v_add_u32 v244, 8, v244
    s_add_u32 s44, s44, 2
    s_cmp_eq_u32 s41, s42
    ds_write2st64_b32 v252, v184, v186 offset0:0 offset1:1
    ds_write2st64_b32 v252, v188, v190 offset0:2 offset1:3
    ds_write2st64_b32 v252, v192, v194 offset0:4 offset1:5
    ds_write2st64_b32 v252, v196, v198 offset0:6 offset1:7
    ds_write2st64_b32 v252, v200, v202 offset0:8 offset1:9
    ds_write_b32 v252, v204 offset:2560
    ds_write_b32 v253, v247
    s_cbranch_scc1 B_exit
    ds_read_b32 v245, v244
    v_readlane_b32 s69, v246, s44
    s_not_b32 s43, s41
    s_min_u32 s41, s69, s42
    s_add_u32 s43, s43, s41
B_M6:
    v_mul_f32 v184, v120, v14
    v_mul_f32 v186, v124, v38
    v_mul_f32 v242, v120, v62
    v_mul_f32 v190, v121, v86
    v_mul_f32 v196, v122, v86
    v_mul_f32 v202, v123, v86
    s_waitcnt vmcnt(12) lgkmcnt(0)
    v_add_u32 v206, v219, v237
    v_mfma_f32_32x32x16_bf16 v[136:151], v[208:211], v[164:167], 0
    ds_read_b64_tr_b16 v[208:209], v235 offset:384
    ds_read_b64_tr_b16 v[210:211], v232 offset:384
    ds_read_b128 v[220:223], v236 offset:224
    global_load_dword v164, v206, s[4:5] offset:0
    global_load_dword v165, v206, s[4:5] offset:256
    global_load_dword v166, v206, s[4:5] offset:512
    global_load_dword v167, v206, s[4:5] offset:768
    s_sub_u32 s43, s43, 1
    v_mul_f32 v192, v125, v110
    v_mul_f32 v198, v126, v110
    v_mul_f32 v204, v127, v110
    v_mul_f32 v188, v242, v216
    v_mul_f32 v194, v242, v217
    v_mul_f32 v200, v242, v218
    v_mul_f32 v185, v128, v22
    v_mul_f32 v187, v132, v46
    v_mul_f32 v243, v128, v70
    v_mul_f32 v191, v129, v94
    v_mul_f32 v197, v130, v94
    v_mul_f32 v203, v131, v94
    v_mul_f32 v189, v243, v216
    v_mul_f32 v195, v243, v217
    v_mul_f32 v201, v243, v218
    v_mul_f32 v193, v133, v118
    v_mul_f32 v199, v134, v118
    v_mul_f32 v205, v135, v118
    s_cbranch_scc0 B_N7
B_FL6:
    v_add_u32 v252, v245, v247
    s_cmp_ge_u32 s41, s63
    s_cbranch_scc1 B_FC6
B_FP6:
    v_cvt_pk_bf16_f32 v184, v184, v185
    v_cvt_pk_bf16_f32 v186, v186, v187
    v_cvt_pk_bf16_f32 v188, v188, v189
    v_cvt_pk_bf16_f32 v190, v190, v191
    v_cvt_pk_bf16_f32 v192, v192, v193
    v_cvt_pk_bf16_f32 v194, v194, v195
    v_cvt_pk_bf16_f32 v196, v196, v197
    v_cvt_pk_bf16_f32 v198, v198, v199
    v_cvt_pk_bf16_f32 v200, v200, v201
    v_cvt_pk_bf16_f32 v202, v202, v203
    v_cvt_pk_bf16_f32 v204, v204, v205
    v_add_u32 v244, 8, v244
    s_add_u32 s44, s44, 2
    s_cmp_eq_u32 s41, s42
    ds_write2st64_b32 v252, v184, v186 offset0:0 offset1:1
    ds_write2st64_b32 v252, v188, v190 offset0:2 offset1:3
    ds_write2st64_b32 v252, v192, v194 offset0:4 offset1:5
    ds_write2st64_b32 v252, v196, v198 offset0:6 offset1:7
    ds_write2st64_b32 v252, v200, v202 offset0:8 offset1:9
    ds_write_b32 v252, v204 offset:2560
    ds_write_b32 v253, v247
    s_cbranch_scc1 B_exit
    ds_read_b32 v245, v244
    v_readlane_b32 s69, v246, s44
    s_not_b32 s43, s41
    s_min_u32 s41, s69, s42
    s_add_u32 s43, s43, s41
B_M7:
    v_mul_f32 v184, v136, v15
    v_mul_f32 v186, v140, v39
    v_mul_f32 v242, v136, v63
    v_mul_f32 v190, v137, v87
    v_mul_f32 v196, v138, v87
    v_mul_f32 v202, v139, v87
    s_waitcnt vmcnt(12) lgkmcnt(0)
    v_add_u32 v206, v223, v237
    v_mfma_f32_32x32x16_bf16 v[120:135], v[208:211], v[152:155], 0
    ds_read_b64_tr_b16 v[208:209], v235 offset:432
    ds_read_b64_tr_b16 v[210:211], v232 offset:432
    ds_read_b128 v[216:219], v236 offset:256
    global_load_dword v152, v206, s[4:5] offset:0
    global_load_dword v153, v206, s[4:5] offset:256
    global_load_dword v154, v206, s[4:5] offset:512
    global_load_dword v155, v206, s[4:5] offset:768
    s_sub_u32 s43, s43, 1
    v_mul_f32 v192, v141, v111
    v_mul_f32 v198, v142, v111
    v_mul_f32 v204, v143, v111
    v_mul_f32 v188, v242, v220
    v_mul_f32 v194, v242, v221
    v_mul_f32 v200, v242, v222
    v_mul_f32 v185, v144, v23
    v_mul_f32 v187, v148, v47
    v_mul_f32 v243, v144, v71
    v_mul_f32 v191, v145, v95
    v_mul_f32 v197, v146, v95
    v_mul_f32 v203, v147, v95
    v_mul_f32 v189, v243, v220
    v_mul_f32 v195, v243, v221
    v_mul_f32 v201, v243, v222
    v_mul_f32 v193, v149, v119
    v_mul_f32 v199, v150, v119
    v_mul_f32 v205, v151, v119
    s_cbranch_scc0 B_N8
B_FL7:
    v_add_u32 v252, v245, v247
    s_cmp_ge_u32 s41, s63
    s_cbranch_scc1 B_FC7
B_FP7:
    v_cvt_pk_bf16_f32 v184, v184, v185
    v_cvt_pk_bf16_f32 v186, v186, v187
    v_cvt_pk_bf16_f32 v188, v188, v189
    v_cvt_pk_bf16_f32 v190, v190, v191
    v_cvt_pk_bf16_f32 v192, v192, v193
    v_cvt_pk_bf16_f32 v194, v194, v195
    v_cvt_pk_bf16_f32 v196, v196, v197
    v_cvt_pk_bf16_f32 v198, v198, v199
    v_cvt_pk_bf16_f32 v200, v200, v201
    v_cvt_pk_bf16_f32 v202, v202, v203
    v_cvt_pk_bf16_f32 v204, v204, v205
    v_add_u32 v244, 8, v244
    s_add_u32 s44, s44, 2
    s_cmp_eq_u32 s41, s42
    ds_write2st64_b32 v252, v184, v186 offset0:0 offset1:1
    ds_write2st64_b32 v252, v188, v190 offset0:2 offset1:3
    ds_write2st64_b32 v252, v192, v194 offset0:4 offset1:5
    ds_write2st64_b32 v252, v196, v198 offset0:6 offset1:7
    ds_write2st64_b32 v252, v200, v202 offset0:8 offset1:9
    ds_write_b32 v252, v204 offset:2560
    ds_write_b32 v253, v247
    s_cbranch_scc1 B_exit
    ds_read_b32 v245, v244
    v_readlane_b32 s69, v246, s44
    s_not_b32 s43, s41
    s_min_u32 s41, s69, s42
    s_add_u32 s43, s43, s41
B_M8:
    s_waitcnt vmcnt(12) lgkmcnt(0)
    v_mfma_f32_32x32x16_bf16 v[8:23], v[224:227], v[32:35], 0
    v_mul_f32 v184, v120, v0
    v_mul_f32 v186, v124, v24
    v_mul_f32 v242, v120, v48
    v_mfma_f32_32x32x16_bf16 v[32:47], v[224:227], v[56:59], 0
    v_mul_f32 v190, v121, v72
    v_mul_f32 v196, v122, v72
    v_mul_f32 v202, v123, v72
    v_mfma_f32_32x32x16_bf16 v[56:71], v[224:227], v[80:83], 0
    v_add_u32 v206, v219, v237
    v_mfma_f32_32x32x16_bf16 v[80:95], v[224:227], v[172:175], 0
    v_mul_f32 v188, v242, v216
    v_mul_f32 v194, v242, v217
    v_mul_f32 v200, v242, v218
    v_mfma_f32_32x32x16_bf16 v[104:119], v[224:227], v[176:179], 0
    v_mul_f32 v192, v125, v96
    v_mul_f32 v198, v126, v96
    v_mul_f32 v204, v127, v96
    v_mfma_f32_32x32x16_bf16 v[136:151], v[208:211], v[156:159], 0
    ds_read_b64_tr_b16 v[208:209], v235 offset:480
    ds_read_b64_tr_b16 v[210:211], v232 offset:480
    ds_read_b128 v[220:223], v236 offset:288
    global_load_dword v156, v206, s[4:5] offset:0
    global_load_dword v157, v206, s[4:5] offset:256
    global_load_dword v158, v206, s[4:5] offset:512
    global_load_dword v159, v206, s[4:5] offset:768
    s_mov_b64 exec, s[56:57]
    buffer_load_dwordx4 v[224:227], v241, s[12:15], s64 offen
    s_mov_b64 exec, -1
    s_sub_u32 s43, s43, 1
    v_mul_f32 v185, v128, v8
    v_mul_f32 v187, v132, v32
    v_mul_f32 v243, v128, v56
    v_mul_f32 v191, v129, v80
    v_mul_f32 v197, v130, v80
    v_mul_f32 v203, v131, v80
    v_mul_f32 v189, v243, v216
    v_mul_f32 v195, v243, v217
    v_mul_f32 v201, v243, v218
    v_mul_f32 v193, v133, v104
    v_mul_f32 v199, v134, v104
    v_mul_f32 v205, v135, v104
    s_cbranch_scc0 B_N9
B_FL8:
    v_add_u32 v252, v245, v247
    s_cmp_ge_u32 s41, s63
    s_cbranch_scc1 B_FC8
B_FP8:
    v_cvt_pk_bf16_f32 v184, v184, v185
    v_cvt_pk_bf16_f32 v186, v186, v187
    v_cvt_pk_bf16_f32 v188, v188, v189
    v_cvt_pk_bf16_f32 v190, v190, v191
    v_cvt_pk_bf16_f32 v192, v192, v193
    v_cvt_pk_bf16_f32 v194, v194, v195
    v_cvt_pk_bf16_f32 v196, v196, v197
    v_cvt_pk_bf16_f32 v198, v198, v199
    v_cvt_pk_bf16_f32 v200, v200, v201
    v_cvt_pk_bf16_f32 v202, v202, v203
    v_cvt_pk_bf16_f32 v204, v204, v205
    v_add_u32 v244, 8, v244
    s_add_u32 s44, s44, 2
    s_cmp_eq_u32 s41, s42
    ds_write2st64_b32 v252, v184, v186 offset0:0 offset1:1
    ds_write2st64_b32 v252, v188, v190 offset0:2 offset1:3
    ds_write2st64_b32 v252, v192, v194 offset0:4 offset1:5
    ds_write2st64_b32 v252, v196, v198 offset0:6 offset1:7
    ds_write2st64_b32 v252, v200, v202 offset0:8 offset1:9
    ds_write_b32 v252, v204 offset:2560
    ds_write_b32 v253, v247
    s_cbranch_scc1 B_exit
    ds_read_b32 v245, v244
    v_readlane_b32 s69, v246, s44
    s_not_b32 s43, s41
    s_min_u32 s41, s69, s42
    s_add_u32 s43, s43, s41
B_M9:
    v_mul_f32 v184, v136, v1
    v_mul_f32 v186, v140, v25
    v_mul_f32 v242, v136, v49
    v_mul_f32 v190, v137, v73
    v_mul_f32 v196, v138, v73
    v_mul_f32 v202, v139, v73
    s_waitcnt vmcnt(13) lgkmcnt(0)
    v_add_u32 v206, v223, v237
    v_mfma_f32_32x32x16_bf16 v[120:135], v[208:211], v[160:163], 0
    ds_read_b64_tr_b16 v[208:209], v235 offset:528
    ds_read_b64_tr_b16 v[210:211], v232 offset:528
    ds_read_b128 v[216:219], v236 offset:320
    global_load_dword v160, v206, s[4:5] offset:0
    global_load_dword v161, v206, s[4:5] offset:256
    global_load_dword v162, v206, s[4:5] offset:512
    global_load_dword v163, v206, s[4:5] offset:768
    s_sub_u32 s43, s43, 1
    v_mul_f32 v192, v141, v97
    v_mul_f32 v198, v142, v97
    v_mul_f32 v204, v143, v97
    v_mul_f32 v188, v242, v220
    v_mul_f32 v194, v242, v221
    v_mul_f32 v200, v242, v222
    v_mul_f32 v185, v144, v9
    v_mul_f32 v187, v148, v33
    v_mul_f32 v243, v144, v57
    v_mul_f32 v191, v145, v81
    v_mul_f32 v197, v146, v81
    v_mul_f32 v203, v147, v81
    v_mul_f32 v189, v243, v220
    v_mul_f32 v195, v243, v221
    v_mul_f32 v201, v243, v222
    v_mul_f32 v193, v149, v105
    v_mul_f32 v199, v150, v105
    v_mul_f32 v205, v151, v105
    s_cbranch_scc0 B_N10
B_FL9:
    v_add_u32 v252, v245, v247
    s_cmp_ge_u32 s41, s63
    s_cbranch_scc1 B_FC9
B_FP9:
    v_cvt_pk_bf16_f32 v184, v184, v185
    v_cvt_pk_bf16_f32 v186, v186, v187
    v_cvt_pk_bf16_f32 v188, v188, v189
    v_cvt_pk_bf16_f32 v190, v190, v191
    v_cvt_pk_bf16_f32 v192, v192, v193
    v_cvt_pk_bf16_f32 v194, v194, v195
    v_cvt_pk_bf16_f32 v196, v196, v197
    v_cvt_pk_bf16_f32 v198, v198, v199
    v_cvt_pk_bf16_f32 v200, v200, v201
    v_cvt_pk_bf16_f32 v202, v202, v203
    v_cvt_pk_bf16_f32 v204, v204, v205
    v_add_u32 v244, 8, v244
    s_add_u32 s44, s44, 2
    s_cmp_eq_u32 s41, s42
    ds_write2st64_b32 v252, v184, v186 offset0:0 offset1:1
    ds_write2st64_b32 v252, v188, v190 offset0:2 offset1:3
    ds_write2st64_b32 v252, v192, v194 offset0:4 offset1:5
    ds_write2st64_b32 v252, v196, v198 offset0:6 offset1:7
    ds_write2st64_b32 v252, v200, v202 offset0:8 offset1:9
    ds_write_b32 v252, v204 offset:2560
    ds_write_b32 v253, v247
    s_cbranch_scc1 B_exit
    ds_read_b32 v245, v244
    v_readlane_b32 s69, v246, s44
    s_not_b32 s43, s41
    s_min_u32 s41, s69, s42
    s_add_u32 s43, s43, s41
B_M10:
    v_mul_f32 v184, v120, v2
    v_mul_f32 v186, v124, v26
    v_mul_f32 v242, v120, v50
    v_mul_f32 v190, v121, v74
    v_mul_f32 v196, v122, v74
    v_mul_f32 v202, v123, v74
    s_waitcnt vmcnt(13) lgkmcnt(0)
    v_add_u32 v206, v219, v237
    v_mfma_f32_32x32x16_bf16 v[136:151], v[208:211], v[164:167], 0
    ds_read_b64_tr_b16 v[208:209], v235 offset:576
    ds_read_b64_tr_b16 v[210:211], v232 offset:576
    ds_read_b128 v[220:223], v236 offset:352
    global_load_dword v164, v206, s[4:5] offset:0
    global_load_dword v165, v206, s[4:5] offset:256
    global_load_dword v166, v206, s[4:5] offset:512
    global_load_dword v167, v206, s[4:5] offset:768
    s_sub_u32 s43, s43, 1
    v_mul_f32 v192, v125, v98
    v_mul_f32 v198, v126, v98
    v_mul_f32 v204, v127, v98
    v_mul_f32 v188, v242, v216
    v_mul_f32 v194, v242, v217
    v_mul_f32 v200, v242, v218
    v_mul_f32 v185, v128, v10
    v_mul_f32 v187, v132, v34
    v_mul_f32 v243, v128, v58
    v_mul_f32 v191, v129, v82
    v_mul_f32 v197, v130, v82
    v_mul_f32 v203, v131, v82
    v_mul_f32 v189, v243, v216
    v_mul_f32 v195, v243, v217
    v_mul_f32 v201, v243, v218
    v_mul_f32 v193, v133, v106
    v_mul_f32 v199, v134, v106
    v_mul_f32 v205, v135, v106
    s_cbranch_scc0 B_N11
B_FL10:
    v_add_u32 v252, v245, v247
    s_cmp_ge_u32 s41, s63
    s_cbranch_scc1 B_FC10
B_FP10:
    v_cvt_pk_bf16_f32 v184, v184, v185
    v_cvt_pk_bf16_f32 v186, v186, v187
    v_cvt_pk_bf16_f32 v188, v188, v189
    v_cvt_pk_bf16_f32 v190, v190, v191
    v_cvt_pk_bf16_f32 v192, v192, v193
    v_cvt_pk_bf16_f32 v194, v194, v195
    v_cvt_pk_bf16_f32 v196, v196, v197
    v_cvt_pk_bf16_f32 v198, v198, v199
    v_cvt_pk_bf16_f32 v200, v200, v201
    v_cvt_pk_bf16_f32 v202, v202, v203
    v_cvt_pk_bf16_f32 v204, v204, v205
    v_add_u32 v244, 8, v244
    s_add_u32 s44, s44, 2
    s_cmp_eq_u32 s41, s42
    ds_write2st64_b32 v252, v184, v186 offset0:0 offset1:1
    ds_write2st64_b32 v252, v188, v190 offset0:2 offset1:3
    ds_write2st64_b32 v252, v192, v194 offset0:4 offset1:5
    ds_write2st64_b32 v252, v196, v198 offset0:6 offset1:7
    ds_write2st64_b32 v252, v200, v202 offset0:8 offset1:9
    ds_write_b32 v252, v204 offset:2560
    ds_write_b32 v253, v247
    s_cbranch_scc1 B_exit
    ds_read_b32 v245, v244
    v_readlane_b32 s69, v246, s44
    s_not_b32 s43, s41
    s_min_u32 s41, s69, s42
    s_add_u32 s43, s43, s41
B_M11:
    v_mul_f32 v184, v136, v3
    v_mul_f32 v186, v140, v27
    v_mul_f32 v242, v136, v51
    v_mul_f32 v190, v137, v75
    v_mul_f32 v196, v138, v75
    v_mul_f32 v202, v139, v75
    s_waitcnt vmcnt(13) lgkmcnt(0)
    v_add_u32 v237, s52, v237
    v_add_u32 v206, v223, v237
    v_mfma_f32_32x32x16_bf16 v[120:135], v[208:211], v[152:155], 0
    ds_read_b64_tr_b16 v[208:209], v235 offset:624
    ds_read_b64_tr_b16 v[210:211], v232 offset:624
    ds_read_b128 v[216:219], v236 offset:384
    global_load_dword v152, v206, s[4:5] offset:0
    global_load_dword v153, v206, s[4:5] offset:256
    global_load_dword v154, v206, s[4:5] offset:512
    global_load_dword v155, v206, s[4:5] offset:768
    s_sub_u32 s43, s43, 1
    v_mul_f32 v192, v141, v99
    v_mul_f32 v198, v142, v99
    v_mul_f32 v204, v143, v99
    v_mul_f32 v188, v242, v220
    v_mul_f32 v194, v242, v221
    v_mul_f32 v200, v242, v222
    v_mul_f32 v185, v144, v11
    v_mul_f32 v187, v148, v35
    v_mul_f32 v243, v144, v59
    v_mul_f32 v191, v145, v83
    v_mul_f32 v197, v146, v83
    v_mul_f32 v203, v147, v83
    v_mul_f32 v189, v243, v220
    v_mul_f32 v195, v243, v221
    v_mul_f32 v201, v243, v222
    v_mul_f32 v193, v149, v107
    v_mul_f32 v199, v150, v107
    v_mul_f32 v205, v151, v107
    s_cbranch_scc0 B_N12
B_FL11:
    v_add_u32 v252, v245, v247
    s_cmp_ge_u32 s41, s63
    s_cbranch_scc1 B_FC11
B_FP11:
    v_cvt_pk_bf16_f32 v184, v184, v185
    v_cvt_pk_bf16_f32 v186, v186, v187
    v_cvt_pk_bf16_f32 v188, v188, v189
    v_cvt_pk_bf16_f32 v190, v190, v191
    v_cvt_pk_bf16_f32 v192, v192, v193
    v_cvt_pk_bf16_f32 v194, v194, v195
    v_cvt_pk_bf16_f32 v196, v196, v197
    v_cvt_pk_bf16_f32 v198, v198, v199
    v_cvt_pk_bf16_f32 v200, v200, v201
    v_cvt_pk_bf16_f32 v202, v202, v203
    v_cvt_pk_bf16_f32 v204, v204, v205
    v_add_u32 v244, 8, v244
    s_add_u32 s44, s44, 2
    s_cmp_eq_u32 s41, s42
    ds_write2st64_b32 v252, v184, v186 offset0:0 offset1:1
    ds_write2st64_b32 v252, v188, v190 offset0:2 offset1:3
    ds_write2st64_b32 v252, v192, v194 offset0:4 offset1:5
    ds_write2st64_b32 v252, v196, v198 offset0:6 offset1:7
    ds_write2st64_b32 v252, v200, v202 offset0:8 offset1:9
    ds_write_b32 v252, v204 offset:2560
    ds_write_b32 v253, v247
    s_cbranch_scc1 B_exit
    ds_read_b32 v245, v244
    v_readlane_b32 s69, v246, s44
    s_not_b32 s43, s41
    s_min_u32 s41, s69, s42
    s_add_u32 s43, s43, s41
B_M12:
    v_mul_f32 v184, v120, v4
    v_mul_f32 v186, v124, v28
    v_mul_f32 v242, v120, v52
    v_mul_f32 v190, v121, v76
    v_mul_f32 v196, v122, v76
    v_mul_f32 v202, v123, v76
    s_waitcnt vmcnt(13) lgkmcnt(0)
    v_add_u32 v206, v219, v237
    v_add_u32 v240, s50, v240
    v_mfma_f32_32x32x16_bf16 v[136:151], v[208:211], v[156:159], 0
    ds_read_b64_tr_b16 v[208:209], v235 offset:672
    ds_read_b64_tr_b16 v[210:211], v232 offset:672
    ds_read_b128 v[220:223], v236 offset:416
    ds_read_b128 v[24:27], v240 offset:0
    ds_read_b128 v[48:51], v240 offset:1024
    global_load_dword v156, v206, s[4:5] offset:0
    global_load_dword v157, v206, s[4:5] offset:256
    global_load_dword v158, v206, s[4:5] offset:512
    global_load_dword v159, v206, s[4:5] offset:768
    s_sub_u32 s43, s43, 1
    v_mul_f32 v192, v125, v100
    v_mul_f32 v198, v126, v100
    v_mul_f32 v204, v127, v100
    v_mul_f32 v188, v242, v216
    v_mul_f32 v194, v242, v217
    v_mul_f32 v200, v242, v218
    v_mul_f32 v185, v128, v12
    v_mul_f32 v187, v132, v36
    v_mul_f32 v243, v128, v60
    v_mul_f32 v191, v129, v84
    v_mul_f32 v197, v130, v84
    v_mul_f32 v203, v131, v84
    v_mul_f32 v189, v243, v216
    v_mul_f32 v195, v243, v217
    v_mul_f32 v201, v243, v218
    v_mul_f32 v193, v133, v108
    v_mul_f32 v199, v134, v108
    v_mul_f32 v205, v135, v108
    s_cbranch_scc0 B_N13
B_FL12:
    v_add_u32 v252, v245, v247
    s_cmp_ge_u32 s41, s63
    s_cbranch_scc1 B_FC12
B_FP12:
    v_cvt_pk_bf16_f32 v184, v184, v185
    v_cvt_pk_bf16_f32 v186, v186, v187
    v_cvt_pk_bf16_f32 v188, v188, v189
    v_cvt_pk_bf16_f32 v190, v190, v191
    v_cvt_pk_bf16_f32 v192, v192, v193
    v_cvt_pk_bf16_f32 v194, v194, v195
    v_cvt_pk_bf16_f32 v196, v196, v197
    v_cvt_pk_bf16_f32 v198, v198, v199
    v_cvt_pk_bf16_f32 v200, v200, v201
    v_cvt_pk_bf16_f32 v202, v202, v203
    v_cvt_pk_bf16_f32 v204, v204, v205
    v_add_u32 v244, 8, v244
    s_add_u32 s44, s44, 2
    s_cmp_eq_u32 s41, s42
    ds_write2st64_b32 v252, v184, v186 offset0:0 offset1:1
    ds_write2st64_b32 v252, v188, v190 offset0:2 offset1:3
    ds_write2st64_b32 v252, v192, v194 offset0:4 offset1:5
    ds_write2st64_b32 v252, v196, v198 offset0:6 offset1:7
    ds_write2st64_b32 v252, v200, v202 offset0:8 offset1:9
    ds_write_b32 v252, v204 offset:2560
    ds_write_b32 v253, v247
    s_cbranch_scc1 B_exit
    ds_read_b32 v245, v244
    v_readlane_b32 s69, v246, s44
    s_not_b32 s43, s41
    s_min_u32 s41, s69, s42
    s_add_u32 s43, s43, s41
B_M13:
    v_mul_f32 v184, v136, v5
    v_mul_f32 v186, v140, v29
    v_mul_f32 v242, v136, v53
    v_mul_f32 v190, v137, v77
    v_mul_f32 v196, v138, v77
    v_mul_f32 v202, v139, v77
    s_waitcnt vmcnt(12) lgkmcnt(0)
    v_add_u32 v206, v223, v237
    v_mfma_f32_32x32x16_bf16 v[120:135], v[208:211], v[160:163], 0
    ds_read_b64_tr_b16 v[208:209], v235 offset:720
    ds_read_b64_tr_b16 v[210:211], v232 offset:720
    ds_read_b128 v[216:219], v236 offset:448
    ds_read_b128 v[72:75], v240 offset:2048
    ds_read_b128 v[96:99], v240 offset:3072
    global_load_dword v160, v206, s[4:5] offset:0
    global_load_dword v161, v206, s[4:5] offset:256
    global_load_dword v162, v206, s[4:5] offset:512
    global_load_dword v163, v206, s[4:5] offset:768
    s_sub_u32 s43, s43, 1
    v_mul_f32 v192, v141, v101
    v_mul_f32 v198, v142, v101
    v_mul_f32 v204, v143, v101
    v_mul_f32 v188, v242, v220
    v_mul_f32 v194, v242, v221
    v_mul_f32 v200, v242, v222
    v_mul_f32 v185, v144, v13
    v_mul_f32 v187, v148, v37
    v_mul_f32 v243, v144, v61
    v_mul_f32 v191, v145, v85
    v_mul_f32 v197, v146, v85
    v_mul_f32 v203, v147, v85
    v_mul_f32 v189, v243, v220
    v_mul_f32 v195, v243, v221
    v_mul_f32 v201, v243, v222
    v_mul_f32 v193, v149, v109
    v_mul_f32 v199, v150, v109
    v_mul_f32 v205, v151, v109
    s_cbranch_scc0 B_N14
B_FL13:
    v_add_u32 v252, v245, v247
    s_cmp_ge_u32 s41, s63
    s_cbranch_scc1 B_FC13
B_FP13:
    v_cvt_pk_bf16_f32 v184, v184, v185
    v_cvt_pk_bf16_f32 v186, v186, v187
    v_cvt_pk_bf16_f32 v188, v188, v189
    v_cvt_pk_bf16_f32 v190, v190, v191
    v_cvt_pk_bf16_f32 v192, v192, v193
    v_cvt_pk_bf16_f32 v194, v194, v195
    v_cvt_pk_bf16_f32 v196, v196, v197
    v_cvt_pk_bf16_f32 v198, v198, v199
    v_cvt_pk_bf16_f32 v200, v200, v201
    v_cvt_pk_bf16_f32 v202, v202, v203
    v_cvt_pk_bf16_f32 v204, v204, v205
    v_add_u32 v244, 8, v244
    s_add_u32 s44, s44, 2
    s_cmp_eq_u32 s41, s42
    ds_write2st64_b32 v252, v184, v186 offset0:0 offset1:1
    ds_write2st64_b32 v252, v188, v190 offset0:2 offset1:3
    ds_write2st64_b32 v252, v192, v194 offset0:4 offset1:5
    ds_write2st64_b32 v252, v196, v198 offset0:6 offset1:7
    ds_write2st64_b32 v252, v200, v202 offset0:8 offset1:9
    ds_write_b32 v252, v204 offset:2560
    ds_write_b32 v253, v247
    s_cbranch_scc1 B_exit
    ds_read_b32 v245, v244
    v_readlane_b32 s69, v246, s44
    s_not_b32 s43, s41
    s_min_u32 s41, s69, s42
    s_add_u32 s43, s43, s41
B_M14:
    v_mul_f32 v184, v120, v6
    v_mul_f32 v186, v124, v30
    v_mul_f32 v242, v120, v54
    v_mul_f32 v190, v121, v78
    v_mul_f32 v196, v122, v78
    v_mul_f32 v202, v123, v78
    s_waitcnt vmcnt(12) lgkmcnt(0)
    v_add_u32 v206, v219, v237
    v_mad_i32_i24 v235, v239, s98, v235
    v_mad_i32_i24 v232, v233, s98, v232
    v_mfma_f32_32x32x16_bf16 v[136:151], v[208:211], v[164:167], 0
    ds_read_b64_tr_b16 v[208:209], v235 offset:0
    ds_read_b64_tr_b16 v[210:211], v232 offset:0
    ds_read_b128 v[220:223], v236 offset:480
    global_load_dword v164, v206, s[4:5] offset:0
    global_load_dword v165, v206, s[4:5] offset:256
    global_load_dword v166, v206, s[4:5] offset:512
    global_load_dword v167, v206, s[4:5] offset:768
    s_sub_u32 s43, s43, 1
    v_mul_f32 v192, v125, v102
    v_mul_f32 v198, v126, v102
    v_mul_f32 v204, v127, v102
    v_mul_f32 v188, v242, v216
    v_mul_f32 v194, v242, v217
    v_mul_f32 v200, v242, v218
    v_mul_f32 v185, v128, v14
    v_mul_f32 v187, v132, v38
    v_mul_f32 v243, v128, v62
    v_mul_f32 v191, v129, v86
    v_mul_f32 v197, v130, v86
    v_mul_f32 v203, v131, v86
    v_mul_f32 v189, v243, v216
    v_mul_f32 v195, v243, v217
    v_mul_f32 v201, v243, v218
    v_mul_f32 v193, v133, v110
    v_mul_f32 v199, v134, v110
    v_mul_f32 v205, v135, v110
    s_cbranch_scc0 B_N15
B_FL14:
    v_add_u32 v252, v245, v247
    s_cmp_ge_u32 s41, s63
    s_cbranch_scc1 B_FC14
B_FP14:
    v_cvt_pk_bf16_f32 v184, v184, v185
    v_cvt_pk_bf16_f32 v186, v186, v187
    v_cvt_pk_bf16_f32 v188, v188, v189
    v_cvt_pk_bf16_f32 v190, v190, v191
    v_cvt_pk_bf16_f32 v192, v192, v193
    v_cvt_pk_bf16_f32 v194, v194, v195
    v_cvt_pk_bf16_f32 v196, v196, v197
    v_cvt_pk_bf16_f32 v198, v198, v199
    v_cvt_pk_bf16_f32 v200, v200, v201
    v_cvt_pk_bf16_f32 v202, v202, v203
    v_cvt_pk_bf16_f32 v204, v204, v205
    v_add_u32 v244, 8, v244
    s_add_u32 s44, s44, 2
    s_cmp_eq_u32 s41, s42
    ds_write2st64_b32 v252, v184, v186 offset0:0 offset1:1
    ds_write2st64_b32 v252, v188, v190 offset0:2 offset1:3
    ds_write2st64_b32 v252, v192, v194 offset0:4 offset1:5
    ds_write2st64_b32 v252, v196, v198 offset0:6 offset1:7
    ds_write2st64_b32 v252, v200, v202 offset0:8 offset1:9
    ds_write_b32 v252, v204 offset:2560
    ds_write_b32 v253, v247
    s_cbranch_scc1 B_exit
    ds_read_b32 v245, v244
    v_readlane_b32 s69, v246, s44
    s_not_b32 s43, s41
    s_min_u32 s41, s69, s42
    s_add_u32 s43, s43, s41
B_M15:
    v_mul_f32 v184, v136, v7
    v_mul_f32 v186, v140, v31
    v_mul_f32 v242, v136, v55
    v_mul_f32 v190, v137, v79
    v_mul_f32 v196, v138, v79
    v_mul_f32 v202, v139, v79
    s_waitcnt vmcnt(12) lgkmcnt(0)
    v_add_u32 v206, v223, v237
    v_add_u32 v236, s48, v236
    v_mfma_f32_32x32x16_bf16 v[120:135], v[208:211], v[152:155], 0
    ds_read_b64_tr_b16 v[208:209], v235 offset:48
    ds_read_b64_tr_b16 v[210:211], v232 offset:48
    ds_read_b128 v[216:219], v236 offset:0
    global_load_dword v152, v206, s[4:5] offset:0
    global_load_dword v153, v206, s[4:5] offset:256
    global_load_dword v154, v206, s[4:5] offset:512
    global_load_dword v155, v206, s[4:5] offset:768
    s_sub_u32 s43, s43, 1
    v_mul_f32 v192, v141, v103
    v_mul_f32 v198, v142, v103
    v_mul_f32 v204, v143, v103
    v_mul_f32 v188, v242, v220
    v_mul_f32 v194, v242, v221
    v_mul_f32 v200, v242, v222
    v_mul_f32 v185, v144, v15
    v_mul_f32 v187, v148, v39
    v_mul_f32 v243, v144, v63
    v_mul_f32 v191, v145, v87
    v_mul_f32 v197, v146, v87
    v_mul_f32 v203, v147, v87
    v_mul_f32 v189, v243, v220
    v_mul_f32 v195, v243, v221
    v_mul_f32 v201, v243, v222
    v_mul_f32 v193, v149, v111
    v_mul_f32 v199, v150, v111
    v_mul_f32 v205, v151, v111
    s_cbranch_scc0 B_N0
B_FL15:
    v_add_u32 v252, v245, v247
    s_cmp_ge_u32 s41, s63
    s_cbranch_scc1 B_FC15
B_FP15:
    v_cvt_pk_bf16_f32 v184, v184, v185
    v_cvt_pk_bf16_f32 v186, v186, v187
    v_cvt_pk_bf16_f32 v188, v188, v189
    v_cvt_pk_bf16_f32 v190, v190, v191
    v_cvt_pk_bf16_f32 v192, v192, v193
    v_cvt_pk_bf16_f32 v194, v194, v195
    v_cvt_pk_bf16_f32 v196, v196, v197
    v_cvt_pk_bf16_f32 v198, v198, v199
    v_cvt_pk_bf16_f32 v200, v200, v201
    v_cvt_pk_bf16_f32 v202, v202, v203
    v_cvt_pk_bf16_f32 v204, v204, v205
    v_add_u32 v244, 8, v244
    s_add_u32 s44, s44, 2
    s_cmp_eq_u32 s41, s42
    ds_write2st64_b32 v252, v184, v186 offset0:0 offset1:1
    ds_write2st64_b32 v252, v188, v190 offset0:2 offset1:3
    ds_write2st64_b32 v252, v192, v194 offset0:4 offset1:5
    ds_write2st64_b32 v252, v196, v198 offset0:6 offset1:7
    ds_write2st64_b32 v252, v200, v202 offset0:8 offset1:9
    ds_write_b32 v252, v204 offset:2560
    ds_write_b32 v253, v247
    s_cbranch_scc0 B_seg0
    s_cmp_eq_u32 s46, 1
    s_cbranch_scc1 B_exit
    ds_read_b128 v[4:7], v240 offset:4096
    ds_read_b128 v[28:31], v240 offset:5120
    ds_read_b128 v[52:55], v240 offset:6144
    v_swap_b32 v168, v180
    v_swap_b32 v169, v181
    v_swap_b32 v170, v182
    v_swap_b32 v171, v183
    v_swap_b32 v172, v212
    v_swap_b32 v173, v213
    v_swap_b32 v174, v214
    v_swap_b32 v175, v215
    v_swap_b32 v176, v228
    v_swap_b32 v177, v229
    v_swap_b32 v178, v230
    v_swap_b32 v179, v231
    s_mov_b32 s46, 1
    s_mov_b32 s41, s40
    s_sub_u32 s62, s44, s45
    s_lshl_b32 s62, s62, 2
    s_mov_b32 s44, s45
    v_subrev_u32 v244, s62, v244
    v_add_u32 v247, 128, v247
    s_lshl_b32 s62, s42, 5
    s_add_u32 s62, s62, 146156
    v_lshl_add_u32 v242, v251, 4, s62
    v_mov_b32 v243, 0
    s_mov_b64 exec, 0x3ff
    ds_write_b32 v242, v243
    s_mov_b64 exec, -1
    s_setprio 1
    s_waitcnt vmcnt(16) lgkmcnt(0)
    v_mfma_f32_32x32x16_bf16 v[8:23], v[224:227], v[4:7], 0
    v_mfma_f32_32x32x16_bf16 v[32:47], v[224:227], v[28:31], 0
    v_mfma_f32_32x32x16_bf16 v[56:71], v[224:227], v[52:55], 0
    v_mfma_f32_32x32x16_bf16 v[80:95], v[224:227], v[172:175], 0
    v_mfma_f32_32x32x16_bf16 v[104:119], v[224:227], v[176:179], 0
    s_nop 0
B_seg0:
    ds_read_b32 v245, v244
    v_readlane_b32 s69, v246, s44
    s_not_b32 s43, s41
    s_min_u32 s41, s69, s42
    s_add_u32 s43, s43, s41
    s_branch B_M0
B_FC0:
    s_call_b64 s[66:67], B_add0
    s_branch B_FP0
B_FC1:
    s_call_b64 s[66:67], B_add1
    s_branch B_FP1
B_FC2:
    s_call_b64 s[66:67], B_add0
    s_branch B_FP2
B_FC3:
    s_call_b64 s[66:67], B_add1
    s_branch B_FP3
B_FC4:
    s_call_b64 s[66:67], B_add0
    s_branch B_FP4
B_FC5:
    s_call_b64 s[66:67], B_add1
    s_branch B_FP5
B_FC6:
    s_call_b64 s[66:67], B_add0
    s_branch B_FP6
B_FC7:
    s_call_b64 s[66:67], B_add1
    s_branch B_FP7
B_FC8:
    s_call_b64 s[66:67], B_add0
    s_branch B_FP8
B_FC9:
    s_call_b64 s[66:67], B_add1
    s_branch B_FP9
B_FC10:
    s_call_b64 s[66:67], B_add0
    s_branch B_FP10
B_FC11:
    s_call_b64 s[66:67], B_add1
    s_branch B_FP11
B_FC12:
    s_call_b64 s[66:67], B_add0
    s_branch B_FP12
B_FC13:
    s_call_b64 s[66:67], B_add1
    s_branch B_FP13
B_FC14:
    s_call_b64 s[66:67], B_add0
    s_branch B_FP14
B_FC15:
    s_call_b64 s[66:67], B_add1
    s_branch B_FP15
B_add0:
    s_cmp_gt_u32 s69, s63
    s_cbranch_scc0 B_ret0
    s_lshl_b32 s68, s46, 7
    s_cmp_eq_u32 s41, s42
    s_cselect_b32 s68, s68, -1
B_spin0:
    ds_read_b32 v131, v253 offset:4
    ds_read2st64_b32 v[120:121], v252 offset0:0 offset1:1
    ds_read2st64_b32 v[122:123], v252 offset0:2 offset1:3
    ds_read2st64_b32 v[124:125], v252 offset0:4 offset1:5
    ds_read2st64_b32 v[126:127], v252 offset0:6 offset1:7
    ds_read2st64_b32 v[128:129], v252 offset0:8 offset1:9
    ds_read_b32 v130, v252 offset:2560
    s_waitcnt lgkmcnt(0)
    v_readfirstlane_b32 s62, v131
    s_cmp_lt_i32 s62, s68
    s_cbranch_scc1 B_spin0
    v_dot2c_f32_bf16 v184, s96, v120
    v_dot2c_f32_bf16 v185, s97, v120
    v_dot2c_f32_bf16 v186, s96, v121
    v_dot2c_f32_bf16 v187, s97, v121
    v_dot2c_f32_bf16 v188, s96, v122
    v_dot2c_f32_bf16 v189, s97, v122
    v_dot2c_f32_bf16 v190, s96, v123
    v_dot2c_f32_bf16 v191, s97, v123
    v_dot2c_f32_bf16 v192, s96, v124
    v_dot2c_f32_bf16 v193, s97, v124
    v_dot2c_f32_bf16 v194, s96, v125
    v_dot2c_f32_bf16 v195, s97, v125
    v_dot2c_f32_bf16 v196, s96, v126
    v_dot2c_f32_bf16 v197, s97, v126
    v_dot2c_f32_bf16 v198, s96, v127
    v_dot2c_f32_bf16 v199, s97, v127
    v_dot2c_f32_bf16 v200, s96, v128
    v_dot2c_f32_bf16 v201, s97, v128
    v_dot2c_f32_bf16 v202, s96, v129
    v_dot2c_f32_bf16 v203, s97, v129
    v_dot2c_f32_bf16 v204, s96, v130
    v_dot2c_f32_bf16 v205, s97, v130
    s_nop 1
B_ret0:
    s_setpc_b64 s[66:67]
B_add1:
    s_cmp_gt_u32 s69, s63
    s_cbranch_scc0 B_ret1
    s_lshl_b32 s68, s46, 7
    s_cmp_eq_u32 s41, s42
    s_cselect_b32 s68, s68, -1
B_spin1:
    ds_read_b32 v147, v253 offset:4
    ds_read2st64_b32 v[136:137], v252 offset0:0 offset1:1
    ds_read2st64_b32 v[138:139], v252 offset0:2 offset1:3
    ds_read2st64_b32 v[140:141], v252 offset0:4 offset1:5
    ds_read2st64_b32 v[142:143], v252 offset0:6 offset1:7
    ds_read2st64_b32 v[144:145], v252 offset0:8 offset1:9
    ds_read_b32 v146, v252 offset:2560
    s_waitcnt lgkmcnt(0)
    v_readfirstlane_b32 s62, v147
    s_cmp_lt_i32 s62, s68
    s_cbranch_scc1 B_spin1
    v_dot2c_f32_bf16 v184, s96, v136
    v_dot2c_f32_bf16 v185, s97, v136
    v_dot2c_f32_bf16 v186, s96, v137
    v_dot2c_f32_bf16 v187, s97, v137
    v_dot2c_f32_bf16 v188, s96, v138
    v_dot2c_f32_bf16 v189, s97, v138
    v_dot2c_f32_bf16 v190, s96, v139
    v_dot2c_f32_bf16 v191, s97, v139
    v_dot2c_f32_bf16 v192, s96, v140
    v_dot2c_f32_bf16 v193, s97, v140
    v_dot2c_f32_bf16 v194, s96, v141
    v_dot2c_f32_bf16 v195, s97, v141
    v_dot2c_f32_bf16 v196, s96, v142
    v_dot2c_f32_bf16 v197, s97, v142
    v_dot2c_f32_bf16 v198, s96, v143
    v_dot2c_f32_bf16 v199, s97, v143
    v_dot2c_f32_bf16 v200, s96, v144
    v_dot2c_f32_bf16 v201, s97, v144
    v_dot2c_f32_bf16 v202, s96, v145
    v_dot2c_f32_bf16 v203, s97, v145
    v_dot2c_f32_bf16 v204, s96, v146
    v_dot2c_f32_bf16 v205, s97, v146
    s_nop 1
B_ret1:
    s_setpc_b64 s[66:67]
B_exit:
    s_add_u32 s35, s35, s36
    s_cmp_ge_u32 s35, s37
    s_cbranch_scc1 B_gemm
    s_waitcnt vmcnt(0) lgkmcnt(0)
    v_swap_b32 v168, v180
    v_swap_b32 v169, v181
    v_swap_b32 v170, v182
    v_swap_b32 v171, v183
    v_swap_b32 v172, v212
    v_swap_b32 v173, v213
    v_swap_b32 v174, v214
    v_swap_b32 v175, v215
    v_swap_b32 v176, v228
    v_swap_b32 v177, v229
    v_swap_b32 v178, v230
    v_swap_b32 v179, v231
    s_barrier
    s_branch B_round
B_gemm:
    s_waitcnt lgkmcnt(0)
    s_mul_i32 s3, s34, 20480
    s_add_u32 s3, s3, 262144
    v_lshlrev_b32 v252, 4, v251
    s_nop 7
    s_add_u32 s21, s3, 4096
    s_add_u32 s22, s3, 8192
    s_add_u32 s23, s3, 12288
    s_add_u32 s24, s3, 16384
    s_mov_b32 s20, s3
    v_add_u32 v194, 81920, v252
    v_mov_b32 v195, v251
    s_cmp_ge_u32 s34, 4
    s_cbranch_scc1 B_wy
B_wy:
    buffer_load_dwordx4 v[0:3], v252, s[12:15], s20 offen offset:0
    buffer_load_dwordx4 v[4:7], v252, s[12:15], s20 offen offset:1024
    buffer_load_dwordx4 v[16:19], v252, s[12:15], s21 offen offset:0
    buffer_load_dwordx4 v[20:23], v252, s[12:15], s21 offen offset:1024
    buffer_load_dwordx4 v[32:35], v252, s[12:15], s22 offen offset:0
    buffer_load_dwordx4 v[36:39], v252, s[12:15], s22 offen offset:1024
    buffer_load_dwordx4 v[48:51], v252, s[12:15], s23 offen offset:0
    buffer_load_dwordx4 v[52:55], v252, s[12:15], s23 offen offset:1024
    buffer_load_dwordx4 v[64:67], v252, s[12:15], s24 offen offset:0
    buffer_load_dwordx4 v[68:71], v252, s[12:15], s24 offen offset:1024
    buffer_load_dwordx4 v[8:11], v252, s[12:15], s20 offen offset:2048
    buffer_load_dwordx4 v[12:15], v252, s[12:15], s20 offen offset:3072
    buffer_load_dwordx4 v[24:27], v252, s[12:15], s21 offen offset:2048
    buffer_load_dwordx4 v[28:31], v252, s[12:15], s21 offen offset:3072
    buffer_load_dwordx4 v[40:43], v252, s[12:15], s22 offen offset:2048
    buffer_load_dwordx4 v[44:47], v252, s[12:15], s22 offen offset:3072
    buffer_load_dwordx4 v[56:59], v252, s[12:15], s23 offen offset:2048
    buffer_load_dwordx4 v[60:63], v252, s[12:15], s23 offen offset:3072
    buffer_load_dwordx4 v[72:75], v252, s[12:15], s24 offen offset:2048
    buffer_load_dwordx4 v[76:79], v252, s[12:15], s24 offen offset:3072
    s_waitcnt vmcnt(20)
    v_and_b32 v190, 15, v195
    v_lshrrev_b32 v191, 4, v195
    v_mul_u32_u24 v184, 2848, v190
    v_lshl_add_u32 v184, v191, 4, v184
    s_lshl_b32 s3, s34, 5
    s_add_u32 s3, s3, 113920
    v_lshl_add_u32 v192, v191, 3, s3
    s_movk_i32 s3, 1040
    v_mad_u32_u24 v187, v190, s3, v192
    v_and_b32 v190, 7, v195
    v_add_u32 v190, 32, v190
    v_mul_u32_u24 v185, 2848, v190
    v_lshl_add_u32 v185, v191, 4, v185
    v_mad_u32_u24 v188, v190, s3, v192
    v_bfe_u32 v191, v195, 3, 1
    v_mul_u32_u24 v190, 768, v191
    v_add_u32 v186, v185, v190
    v_lshl_add_u32 v189, v191, 8, v188
    s_and_b32 s3, s34, 3
    v_lshrrev_b32 v190, 3, v195
    v_lshl_add_u32 v190, v190, 2, s3
    v_mul_u32_u24 v190, 2848, v190
    v_and_b32 v191, 7, v195
    v_lshl_add_u32 v193, v191, 4, v190
    s_cmp_lt_u32 s34, 4
    s_cbranch_scc1 B_gw
    s_barrier
    s_branch B_g1
B_gw:
    s_setprio 0
    v_and_b32 v190, 7, v195
    v_lshlrev_b32 v190, 2, v190
    v_add_u32 v190, 163152, v190
    v_mov_b32 v192, 128
B_gspin:
    ds_read_b32 v191, v190
    s_waitcnt lgkmcnt(0)
    v_cmp_gt_i32 vcc, v192, v191
    s_cmp_lg_u64 vcc, 0
    s_cbranch_scc1 B_gspin
B_g1:
    ds_read_b128 v[124:127], v184 offset:0
    ds_read_b128 v[128:131], v184 offset:45568
    ds_read_b128 v[132:135], v185 offset:0
    ds_read_b128 v[136:139], v184 offset:64
    ds_read_b128 v[140:143], v184 offset:45632
    ds_read_b128 v[144:147], v185 offset:64
    ds_read_b128 v[148:151], v184 offset:256
    ds_read_b128 v[152:155], v184 offset:45824
    ds_read_b128 v[156:159], v185 offset:256
    ds_read_b128 v[160:163], v184 offset:320
    ds_read_b128 v[164:167], v184 offset:45888
    ds_read_b128 v[168:171], v185 offset:320
    s_waitcnt vmcnt(19) lgkmcnt(9)
    v_mfma_f32_16x16x32_bf16 v[80:83], v[0:3], v[124:127], 0
    v_mfma_f32_16x16x32_bf16 v[84:87], v[0:3], v[128:131], 0
    v_mfma_f32_16x16x32_bf16 v[88:91], v[0:3], v[132:135], 0
    ds_read_b128 v[124:127], v184 offset:512
    ds_read_b128 v[128:131], v184 offset:1280
    ds_read_b128 v[132:135], v184 offset:2048
    s_waitcnt vmcnt(18) lgkmcnt(9)
    v_mfma_f32_16x16x32_bf16 v[80:83], v[4:7], v[136:139], v[80:83]
    v_mfma_f32_16x16x32_bf16 v[84:87], v[4:7], v[140:143], v[84:87]
    v_mfma_f32_16x16x32_bf16 v[88:91], v[4:7], v[144:147], v[88:91]
    ds_read_b128 v[136:139], v184 offset:46080
    ds_read_b128 v[140:143], v184 offset:46848
    ds_read_b128 v[144:147], v184 offset:47616
    s_waitcnt vmcnt(17) lgkmcnt(9)
    v_mfma_f32_16x16x32_bf16 v[80:83], v[16:19], v[148:151], v[80:83]
    v_mfma_f32_16x16x32_bf16 v[84:87], v[16:19], v[152:155], v[84:87]
    v_mfma_f32_16x16x32_bf16 v[88:91], v[16:19], v[156:159], v[88:91]
    ds_read_b128 v[148:151], v186 offset:512
    ds_read_b128 v[152:155], v185 offset:2048
    ds_read_b128 v[156:159], v184 offset:576
    s_waitcnt vmcnt(16) lgkmcnt(9)
    v_mfma_f32_16x16x32_bf16 v[80:83], v[20:23], v[160:163], v[80:83]
    v_mfma_f32_16x16x32_bf16 v[84:87], v[20:23], v[164:167], v[84:87]
    v_mfma_f32_16x16x32_bf16 v[88:91], v[20:23], v[168:171], v[88:91]
    ds_read_b128 v[160:163], v184 offset:1344
    ds_read_b128 v[164:167], v184 offset:2112
    ds_read_b128 v[168:171], v184 offset:46144
    s_waitcnt vmcnt(15) lgkmcnt(9)
    v_mfma_f32_16x16x32_bf16 v[92:95], v[32:35], v[124:127], 0
    v_mfma_f32_16x16x32_bf16 v[96:99], v[32:35], v[128:131], 0
    v_mfma_f32_16x16x32_bf16 v[100:103], v[32:35], v[132:135], 0
    ds_read_b128 v[124:127], v184 offset:46912
    ds_read_b128 v[128:131], v184 offset:47680
    ds_read_b128 v[132:135], v186 offset:576
    s_waitcnt lgkmcnt(9)
    v_mfma_f32_16x16x32_bf16 v[104:107], v[32:35], v[136:139], 0
    v_mfma_f32_16x16x32_bf16 v[108:111], v[32:35], v[140:143], 0
    v_mfma_f32_16x16x32_bf16 v[112:115], v[32:35], v[144:147], 0
    ds_read_b128 v[136:139], v185 offset:2112
    ds_read_b128 v[140:143], v184 offset:768
    ds_read_b128 v[144:147], v184 offset:1536
    s_waitcnt vmcnt(14) lgkmcnt(9)
    v_mfma_f32_16x16x32_bf16 v[116:119], v[32:35], v[148:151], 0
    v_mfma_f32_16x16x32_bf16 v[120:123], v[32:35], v[152:155], 0
    v_mfma_f32_16x16x32_bf16 v[92:95], v[36:39], v[156:159], v[92:95]
    ds_read_b128 v[148:151], v184 offset:2304
    ds_read_b128 v[152:155], v184 offset:46336
    ds_read_b128 v[156:159], v184 offset:47104
    s_waitcnt lgkmcnt(9)
    v_mfma_f32_16x16x32_bf16 v[96:99], v[36:39], v[160:163], v[96:99]
    v_mfma_f32_16x16x32_bf16 v[100:103], v[36:39], v[164:167], v[100:103]
    v_mfma_f32_16x16x32_bf16 v[104:107], v[36:39], v[168:171], v[104:107]
    ds_read_b128 v[160:163], v184 offset:47872
    ds_read_b128 v[164:167], v186 offset:768
    ds_read_b128 v[168:171], v185 offset:2304
    s_waitcnt lgkmcnt(9)
    v_mfma_f32_16x16x32_bf16 v[108:111], v[36:39], v[124:127], v[108:111]
    v_mfma_f32_16x16x32_bf16 v[112:115], v[36:39], v[128:131], v[112:115]
    v_mfma_f32_16x16x32_bf16 v[116:119], v[36:39], v[132:135], v[116:119]
    ds_read_b128 v[124:127], v184 offset:832
    ds_read_b128 v[128:131], v184 offset:1600
    ds_read_b128 v[132:135], v184 offset:2368
    s_waitcnt vmcnt(13) lgkmcnt(9)
    v_mfma_f32_16x16x32_bf16 v[120:123], v[36:39], v[136:139], v[120:123]
    v_mfma_f32_16x16x32_bf16 v[92:95], v[48:51], v[140:143], v[92:95]
    v_mfma_f32_16x16x32_bf16 v[96:99], v[48:51], v[144:147], v[96:99]
    ds_read_b128 v[136:139], v184 offset:46400
    ds_read_b128 v[140:143], v184 offset:47168
    ds_read_b128 v[144:147], v184 offset:47936
    s_waitcnt lgkmcnt(9)
    v_mfma_f32_16x16x32_bf16 v[100:103], v[48:51], v[148:151], v[100:103]
    v_mfma_f32_16x16x32_bf16 v[104:107], v[48:51], v[152:155], v[104:107]
    v_mfma_f32_16x16x32_bf16 v[108:111], v[48:51], v[156:159], v[108:111]
    ds_read_b128 v[148:151], v186 offset:832
    ds_read_b128 v[152:155], v185 offset:2368
    ds_read_b128 v[156:159], v184 offset:1024
    s_waitcnt lgkmcnt(9)
    v_mfma_f32_16x16x32_bf16 v[112:115], v[48:51], v[160:163], v[112:115]
    v_mfma_f32_16x16x32_bf16 v[116:119], v[48:51], v[164:167], v[116:119]
    v_mfma_f32_16x16x32_bf16 v[120:123], v[48:51], v[168:171], v[120:123]
    ds_read_b128 v[160:163], v184 offset:1792
    ds_read_b128 v[164:167], v184 offset:2560
    ds_read_b128 v[168:171], v184 offset:46592
    s_waitcnt vmcnt(12) lgkmcnt(9)
    v_mfma_f32_16x16x32_bf16 v[92:95], v[52:55], v[124:127], v[92:95]
    v_mfma_f32_16x16x32_bf16 v[96:99], v[52:55], v[128:131], v[96:99]
    v_mfma_f32_16x16x32_bf16 v[100:103], v[52:55], v[132:135], v[100:103]
    ds_read_b128 v[124:127], v184 offset:47360
    ds_read_b128 v[128:131], v184 offset:48128
    ds_read_b128 v[132:135], v186 offset:1024
    s_waitcnt lgkmcnt(9)
    v_mfma_f32_16x16x32_bf16 v[104:107], v[52:55], v[136:139], v[104:107]
    v_mfma_f32_16x16x32_bf16 v[108:111], v[52:55], v[140:143], v[108:111]
    v_mfma_f32_16x16x32_bf16 v[112:115], v[52:55], v[144:147], v[112:115]
    ds_read_b128 v[136:139], v185 offset:2560
    ds_read_b128 v[140:143], v184 offset:1088
    ds_read_b128 v[144:147], v184 offset:1856
    s_waitcnt vmcnt(11) lgkmcnt(9)
    v_mfma_f32_16x16x32_bf16 v[116:119], v[52:55], v[148:151], v[116:119]
    v_mfma_f32_16x16x32_bf16 v[120:123], v[52:55], v[152:155], v[120:123]
    v_mfma_f32_16x16x32_bf16 v[92:95], v[64:67], v[156:159], v[92:95]
    ds_read_b128 v[148:151], v184 offset:2624
    ds_read_b128 v[152:155], v184 offset:46656
    ds_read_b128 v[156:159], v184 offset:47424
    s_waitcnt lgkmcnt(9)
    v_mfma_f32_16x16x32_bf16 v[96:99], v[64:67], v[160:163], v[96:99]
    v_mfma_f32_16x16x32_bf16 v[100:103], v[64:67], v[164:167], v[100:103]
    v_mfma_f32_16x16x32_bf16 v[104:107], v[64:67], v[168:171], v[104:107]
    ds_read_b128 v[160:163], v184 offset:48192
    ds_read_b128 v[164:167], v186 offset:1088
    ds_read_b128 v[168:171], v185 offset:2624
    s_waitcnt lgkmcnt(9)
    v_mfma_f32_16x16x32_bf16 v[108:111], v[64:67], v[124:127], v[108:111]
    v_mfma_f32_16x16x32_bf16 v[112:115], v[64:67], v[128:131], v[112:115]
    v_mfma_f32_16x16x32_bf16 v[116:119], v[64:67], v[132:135], v[116:119]
    s_waitcnt vmcnt(10) lgkmcnt(6)
    v_mfma_f32_16x16x32_bf16 v[120:123], v[64:67], v[136:139], v[120:123]
    v_mfma_f32_16x16x32_bf16 v[92:95], v[68:71], v[140:143], v[92:95]
    v_mfma_f32_16x16x32_bf16 v[96:99], v[68:71], v[144:147], v[96:99]
    s_waitcnt lgkmcnt(3)
    v_mfma_f32_16x16x32_bf16 v[100:103], v[68:71], v[148:151], v[100:103]
    v_mfma_f32_16x16x32_bf16 v[104:107], v[68:71], v[152:155], v[104:107]
    v_mfma_f32_16x16x32_bf16 v[108:111], v[68:71], v[156:159], v[108:111]
    s_waitcnt lgkmcnt(0)
    v_mfma_f32_16x16x32_bf16 v[112:115], v[68:71], v[160:163], v[112:115]
    v_mfma_f32_16x16x32_bf16 v[116:119], v[68:71], v[164:167], v[116:119]
    v_mfma_f32_16x16x32_bf16 v[120:123], v[68:71], v[168:171], v[120:123]
    s_cmp_ge_u32 s34, 4
    s_cbranch_scc1 B_g2
    s_waitcnt lgkmcnt(0)
    s_barrier
B_g2:
    ds_read_b128 v[124:127], v184 offset:128
    ds_read_b128 v[128:131], v184 offset:45696
    ds_read_b128 v[132:135], v185 offset:128
    ds_read_b128 v[136:139], v184 offset:192
    ds_read_b128 v[140:143], v184 offset:45760
    ds_read_b128 v[144:147], v185 offset:192
    ds_read_b128 v[148:151], v184 offset:384
    ds_read_b128 v[152:155], v184 offset:45952
    ds_read_b128 v[156:159], v185 offset:384
    ds_read_b128 v[160:163], v184 offset:448
    ds_read_b128 v[164:167], v184 offset:46016
    ds_read_b128 v[168:171], v185 offset:448
    s_waitcnt vmcnt(6) lgkmcnt(9)
    v_mfma_f32_16x16x32_bf16 v[80:83], v[8:11], v[124:127], v[80:83]
    v_mfma_f32_16x16x32_bf16 v[84:87], v[8:11], v[128:131], v[84:87]
    v_mfma_f32_16x16x32_bf16 v[88:91], v[8:11], v[132:135], v[88:91]
    ds_read_b128 v[124:127], v184 offset:640
    ds_read_b128 v[128:131], v184 offset:704
    ds_read_b128 v[132:135], v184 offset:896
    s_waitcnt lgkmcnt(9)
    v_mfma_f32_16x16x32_bf16 v[80:83], v[12:15], v[136:139], v[80:83]
    v_mfma_f32_16x16x32_bf16 v[84:87], v[12:15], v[140:143], v[84:87]
    v_mfma_f32_16x16x32_bf16 v[88:91], v[12:15], v[144:147], v[88:91]
    ds_read_b128 v[136:139], v184 offset:960
    ds_read_b128 v[140:143], v184 offset:1152
    ds_read_b128 v[144:147], v184 offset:1216
    s_waitcnt lgkmcnt(9)
    v_mfma_f32_16x16x32_bf16 v[80:83], v[24:27], v[148:151], v[80:83]
    v_mfma_f32_16x16x32_bf16 v[84:87], v[24:27], v[152:155], v[84:87]
    v_mfma_f32_16x16x32_bf16 v[88:91], v[24:27], v[156:159], v[88:91]
    ds_read_b128 v[148:151], v184 offset:1408
    ds_read_b128 v[152:155], v184 offset:1472
    ds_read_b128 v[156:159], v184 offset:1664
    s_waitcnt lgkmcnt(9)
    v_mfma_f32_16x16x32_bf16 v[80:83], v[28:31], v[160:163], v[80:83]
    v_mfma_f32_16x16x32_bf16 v[84:87], v[28:31], v[164:167], v[84:87]
    v_mfma_f32_16x16x32_bf16 v[88:91], v[28:31], v[168:171], v[88:91]
    ds_read_b128 v[160:163], v184 offset:1728
    ds_read_b128 v[164:167], v184 offset:1920
    ds_read_b128 v[168:171], v184 offset:1984
    s_waitcnt vmcnt(0) lgkmcnt(9)
    v_mfma_f32_16x16x32_bf16 v[92:95], v[40:43], v[124:127], v[92:95]
    v_mfma_f32_16x16x32_bf16 v[92:95], v[44:47], v[128:131], v[92:95]
    v_mfma_f32_16x16x32_bf16 v[92:95], v[56:59], v[132:135], v[92:95]
    ds_read_b128 v[124:127], v184 offset:2176
    ds_read_b128 v[128:131], v184 offset:2240
    ds_read_b128 v[132:135], v184 offset:2432
    s_waitcnt lgkmcnt(9)
    v_mfma_f32_16x16x32_bf16 v[92:95], v[60:63], v[136:139], v[92:95]
    v_mfma_f32_16x16x32_bf16 v[92:95], v[72:75], v[140:143], v[92:95]
    v_mfma_f32_16x16x32_bf16 v[92:95], v[76:79], v[144:147], v[92:95]
    v_mul_f32 v172, 0xbfb8aa3b, v80
    v_mul_f32 v173, 0xbfb8aa3b, v81
    ds_read_b128 v[136:139], v184 offset:2496
    ds_read_b128 v[140:143], v184 offset:2688
    ds_read_b128 v[144:147], v184 offset:2752
    s_waitcnt lgkmcnt(9)
    v_mfma_f32_16x16x32_bf16 v[96:99], v[40:43], v[148:151], v[96:99]
    v_mul_f32 v174, 0xbfb8aa3b, v82
    v_mul_f32 v175, 0xbfb8aa3b, v83
    v_mfma_f32_16x16x32_bf16 v[96:99], v[44:47], v[152:155], v[96:99]
    v_exp_f32 v172, v172
    v_exp_f32 v173, v173
    v_mfma_f32_16x16x32_bf16 v[96:99], v[56:59], v[156:159], v[96:99]
    v_exp_f32 v174, v174
    v_exp_f32 v175, v175
    ds_read_b128 v[148:151], v184 offset:46208
    ds_read_b128 v[152:155], v184 offset:46272
    ds_read_b128 v[156:159], v184 offset:46464
    s_waitcnt lgkmcnt(9)
    v_mfma_f32_16x16x32_bf16 v[96:99], v[60:63], v[160:163], v[96:99]
    v_add_f32 v172, 1.0, v172
    v_add_f32 v173, 1.0, v173
    v_mfma_f32_16x16x32_bf16 v[96:99], v[72:75], v[164:167], v[96:99]
    v_add_f32 v174, 1.0, v174
    v_add_f32 v175, 1.0, v175
    v_mfma_f32_16x16x32_bf16 v[96:99], v[76:79], v[168:171], v[96:99]
    v_rcp_f32 v172, v172
    v_rcp_f32 v173, v173
    ds_read_b128 v[160:163], v184 offset:46528
    ds_read_b128 v[164:167], v184 offset:46720
    ds_read_b128 v[168:171], v184 offset:46784
    s_waitcnt lgkmcnt(9)
    v_mfma_f32_16x16x32_bf16 v[100:103], v[40:43], v[124:127], v[100:103]
    v_rcp_f32 v174, v174
    v_rcp_f32 v175, v175
    v_mfma_f32_16x16x32_bf16 v[100:103], v[44:47], v[128:131], v[100:103]
    v_cvt_pk_bf16_f32 v80, v80, v81
    v_cvt_pk_bf16_f32 v81, v82, v83
    v_mfma_f32_16x16x32_bf16 v[100:103], v[56:59], v[132:135], v[100:103]
    ds_write_b64 v187, v[80:81] offset:0
    v_mul_f32 v176, 0xbfb8aa3b, v84
    ds_read_b128 v[124:127], v184 offset:46976
    ds_read_b128 v[128:131], v184 offset:47040
    ds_read_b128 v[132:135], v184 offset:47232
    s_waitcnt lgkmcnt(10)
    v_mfma_f32_16x16x32_bf16 v[100:103], v[60:63], v[136:139], v[100:103]
    v_mul_f32 v177, 0xbfb8aa3b, v85
    v_mul_f32 v178, 0xbfb8aa3b, v86
    v_mfma_f32_16x16x32_bf16 v[100:103], v[72:75], v[140:143], v[100:103]
    v_mul_f32 v179, 0xbfb8aa3b, v87
    v_exp_f32 v176, v176
    v_mfma_f32_16x16x32_bf16 v[100:103], v[76:79], v[144:147], v[100:103]
    v_exp_f32 v177, v177
    v_exp_f32 v178, v178
    ds_read_b128 v[136:139], v184 offset:47296
    ds_read_b128 v[140:143], v184 offset:47488
    ds_read_b128 v[144:147], v184 offset:47552
    s_waitcnt lgkmcnt(10)
    v_mfma_f32_16x16x32_bf16 v[104:107], v[40:43], v[148:151], v[104:107]
    v_exp_f32 v179, v179
    v_add_f32 v176, 1.0, v176
    v_mfma_f32_16x16x32_bf16 v[104:107], v[44:47], v[152:155], v[104:107]
    v_add_f32 v177, 1.0, v177
    v_add_f32 v178, 1.0, v178
    v_mfma_f32_16x16x32_bf16 v[104:107], v[56:59], v[156:159], v[104:107]
    v_add_f32 v179, 1.0, v179
    v_rcp_f32 v176, v176
    ds_read_b128 v[148:151], v184 offset:47744
    ds_read_b128 v[152:155], v184 offset:47808
    ds_read_b128 v[156:159], v184 offset:48000
    s_waitcnt lgkmcnt(10)
    v_mfma_f32_16x16x32_bf16 v[104:107], v[60:63], v[160:163], v[104:107]
    v_rcp_f32 v177, v177
    v_rcp_f32 v178, v178
    v_mfma_f32_16x16x32_bf16 v[104:107], v[72:75], v[164:167], v[104:107]
    v_rcp_f32 v179, v179
    v_cvt_pk_bf16_f32 v84, v84, v85
    v_mfma_f32_16x16x32_bf16 v[104:107], v[76:79], v[168:171], v[104:107]
    v_cvt_pk_bf16_f32 v85, v86, v87
    ds_write_b64 v187, v[84:85] offset:16640
    ds_read_b128 v[160:163], v184 offset:48064
    ds_read_b128 v[164:167], v184 offset:48256
    ds_read_b128 v[168:171], v184 offset:48320
    s_waitcnt lgkmcnt(10)
    v_mfma_f32_16x16x32_bf16 v[108:111], v[40:43], v[124:127], v[108:111]
    v_mul_f32 v180, 0xbfb8aa3b, v88
    v_mul_f32 v181, 0xbfb8aa3b, v89
    v_mfma_f32_16x16x32_bf16 v[108:111], v[44:47], v[128:131], v[108:111]
    v_mul_f32 v182, 0xbfb8aa3b, v90
    v_mul_f32 v183, 0xbfb8aa3b, v91
    v_mfma_f32_16x16x32_bf16 v[108:111], v[56:59], v[132:135], v[108:111]
    v_exp_f32 v180, v180
    v_exp_f32 v181, v181
    ds_read_b128 v[124:127], v186 offset:640
    ds_read_b128 v[128:131], v186 offset:704
    ds_read_b128 v[132:135], v186 offset:896
    s_waitcnt lgkmcnt(10)
    v_mfma_f32_16x16x32_bf16 v[108:111], v[60:63], v[136:139], v[108:111]
    v_exp_f32 v182, v182
    v_exp_f32 v183, v183
    v_mfma_f32_16x16x32_bf16 v[108:111], v[72:75], v[140:143], v[108:111]
    v_add_f32 v180, 1.0, v180
    v_add_f32 v181, 1.0, v181
    v_mfma_f32_16x16x32_bf16 v[108:111], v[76:79], v[144:147], v[108:111]
    v_add_f32 v182, 1.0, v182
    v_add_f32 v183, 1.0, v183
    ds_read_b128 v[136:139], v186 offset:960
    ds_read_b128 v[140:143], v186 offset:1152
    ds_read_b128 v[144:147], v186 offset:1216
    s_waitcnt lgkmcnt(10)
    v_mfma_f32_16x16x32_bf16 v[112:115], v[40:43], v[148:151], v[112:115]
    v_rcp_f32 v180, v180
    v_rcp_f32 v181, v181
    v_mfma_f32_16x16x32_bf16 v[112:115], v[44:47], v[152:155], v[112:115]
    v_rcp_f32 v182, v182
    v_rcp_f32 v183, v183
    v_mfma_f32_16x16x32_bf16 v[112:115], v[56:59], v[156:159], v[112:115]
    v_cvt_pk_bf16_f32 v88, v88, v89
    v_cvt_pk_bf16_f32 v89, v90, v91
    ds_read_b128 v[148:151], v185 offset:2176
    ds_read_b128 v[152:155], v185 offset:2240
    ds_read_b128 v[156:159], v185 offset:2432
    s_waitcnt lgkmcnt(9)
    v_mfma_f32_16x16x32_bf16 v[112:115], v[60:63], v[160:163], v[112:115]
    ds_write_b64 v188, v[88:89] offset:0
    v_mul_f32 v92, v92, v172
    v_mfma_f32_16x16x32_bf16 v[112:115], v[72:75], v[164:167], v[112:115]
    v_mul_f32 v93, v93, v173
    v_mul_f32 v94, v94, v174
    v_mfma_f32_16x16x32_bf16 v[112:115], v[76:79], v[168:171], v[112:115]
    v_mul_f32 v95, v95, v175
    v_cvt_pk_bf16_f32 v92, v92, v93
    ds_read_b128 v[160:163], v185 offset:2496
    ds_read_b128 v[164:167], v185 offset:2688
    ds_read_b128 v[168:171], v185 offset:2752
    s_waitcnt lgkmcnt(10)
    v_mfma_f32_16x16x32_bf16 v[116:119], v[40:43], v[124:127], v[116:119]
    v_cvt_pk_bf16_f32 v93, v94, v95
    ds_write_b64 v187, v[92:93] offset:256
    v_mfma_f32_16x16x32_bf16 v[116:119], v[44:47], v[128:131], v[116:119]
    v_mul_f32 v96, v96, v172
    v_mul_f32 v97, v97, v173
    v_mfma_f32_16x16x32_bf16 v[116:119], v[56:59], v[132:135], v[116:119]
    v_mul_f32 v98, v98, v174
    v_mul_f32 v99, v99, v175
    s_waitcnt lgkmcnt(8)
    v_mfma_f32_16x16x32_bf16 v[116:119], v[60:63], v[136:139], v[116:119]
    v_cvt_pk_bf16_f32 v96, v96, v97
    v_cvt_pk_bf16_f32 v97, v98, v99
    v_mfma_f32_16x16x32_bf16 v[116:119], v[72:75], v[140:143], v[116:119]
    ds_write_b64 v187, v[96:97] offset:512
    v_mul_f32 v100, v100, v172
    v_mfma_f32_16x16x32_bf16 v[116:119], v[76:79], v[144:147], v[116:119]
    v_mul_f32 v101, v101, v173
    v_mul_f32 v102, v102, v174
    s_waitcnt lgkmcnt(6)
    v_mfma_f32_16x16x32_bf16 v[120:123], v[40:43], v[148:151], v[120:123]
    v_mul_f32 v103, v103, v175
    v_cvt_pk_bf16_f32 v100, v100, v101
    v_mfma_f32_16x16x32_bf16 v[120:123], v[44:47], v[152:155], v[120:123]
    v_cvt_pk_bf16_f32 v101, v102, v103
    ds_write_b64 v187, v[100:101] offset:768
    v_mfma_f32_16x16x32_bf16 v[120:123], v[56:59], v[156:159], v[120:123]
    v_mul_f32 v104, v104, v176
    v_mul_f32 v105, v105, v177
    s_waitcnt lgkmcnt(3)
    v_mfma_f32_16x16x32_bf16 v[120:123], v[60:63], v[160:163], v[120:123]
    v_mul_f32 v106, v106, v178
    v_mul_f32 v107, v107, v179
    v_mfma_f32_16x16x32_bf16 v[120:123], v[72:75], v[164:167], v[120:123]
    v_cvt_pk_bf16_f32 v104, v104, v105
    v_cvt_pk_bf16_f32 v105, v106, v107
    v_mfma_f32_16x16x32_bf16 v[120:123], v[76:79], v[168:171], v[120:123]
    ds_write_b64 v187, v[104:105] offset:16896
    v_mul_f32 v108, v108, v176
    s_nop 7
    v_mul_f32 v109, v109, v177
    v_mul_f32 v110, v110, v178
    v_mul_f32 v111, v111, v179
    v_cvt_pk_bf16_f32 v108, v108, v109
    v_cvt_pk_bf16_f32 v109, v110, v111
    ds_write_b64 v187, v[108:109] offset:17152
    v_mul_f32 v112, v112, v176
    v_mul_f32 v113, v113, v177
    v_mul_f32 v114, v114, v178
    v_mul_f32 v115, v115, v179
    v_cvt_pk_bf16_f32 v112, v112, v113
    v_cvt_pk_bf16_f32 v113, v114, v115
    ds_write_b64 v187, v[112:113] offset:17408
    v_mul_f32 v116, v116, v180
    v_mul_f32 v117, v117, v181
    v_mul_f32 v118, v118, v182
    v_mul_f32 v119, v119, v183
    v_cvt_pk_bf16_f32 v116, v116, v117
    v_cvt_pk_bf16_f32 v117, v118, v119
    ds_write_b64 v189, v[116:117] offset:256
    v_mul_f32 v120, v120, v180
    v_mul_f32 v121, v121, v181
    v_mul_f32 v122, v122, v182
    v_mul_f32 v123, v123, v183
    v_cvt_pk_bf16_f32 v120, v120, v121
    v_cvt_pk_bf16_f32 v121, v122, v123
    ds_write_b64 v188, v[120:121] offset:768
    s_mul_i32 s3, s34, 5200
    s_add_u32 s3, s3, 113920
    v_add_u32 v0, s3, v252
    s_mul_i32 s3, s34, 5
    s_add_u32 s3, s3, s59
    s_lshl_b32 s3, s3, 10
    s_add_u32 s62, s3, 4096
    s_add_u32 s18, s59, s60
    s_lshl_b32 s18, s18, 10
    s_waitcnt lgkmcnt(0)
    s_barrier
    ds_read_b128 v[4:7], v0 offset:0
    ds_read_b128 v[8:11], v0 offset:1040
    ds_read_b128 v[12:15], v0 offset:2080
    ds_read_b128 v[16:19], v0 offset:3120
    ds_read_b128 v[20:23], v0 offset:4160
    s_waitcnt lgkmcnt(4)
    buffer_store_dwordx4 v[4:7], v252, s[16:19], s3 offen offset:0 nt
    s_waitcnt lgkmcnt(3)
    buffer_store_dwordx4 v[8:11], v252, s[16:19], s3 offen offset:1024 nt
    s_waitcnt lgkmcnt(2)
    buffer_store_dwordx4 v[12:15], v252, s[16:19], s3 offen offset:2048 nt
    s_waitcnt lgkmcnt(1)
    buffer_store_dwordx4 v[16:19], v252, s[16:19], s3 offen offset:3072 nt
    s_waitcnt lgkmcnt(0)
    buffer_store_dwordx4 v[20:23], v252, s[16:19], s62 offen offset:0 nt
B_end:
    s_endpgm
.section .rodata,"a"
.p2align 6
.amdhsa_kernel sort_kernel
  .amdhsa_next_free_vgpr 56
  .amdhsa_next_free_sgpr 102
  .amdhsa_accum_offset 56
  .amdhsa_group_segment_fixed_size 0
  .amdhsa_kernarg_size 96
  .amdhsa_user_sgpr_count 2
  .amdhsa_user_sgpr_kernarg_segment_ptr 1
  .amdhsa_system_sgpr_workgroup_id_x 1
.end_amdhsa_kernel
.p2align 6
.amdhsa_kernel gather_scatter__tensor_product_equiv_equiformer__graph_kernel
  .amdhsa_next_free_vgpr 256
  .amdhsa_next_free_sgpr 102
  .amdhsa_accum_offset 256
  .amdhsa_group_segment_fixed_size 0
  .amdhsa_kernarg_size 96
  .amdhsa_user_sgpr_count 2
  .amdhsa_user_sgpr_kernarg_segment_ptr 1
  .amdhsa_system_sgpr_workgroup_id_x 1
.end_amdhsa_kernel
```
